```python
import torch

def _softmax(x, axis=-1):
    return torch.softmax(x, dim=axis)
def _gelu(x):
    return torch.nn.functional.gelu(x, approximate="tanh")
def _silu(x):
    return torch.nn.functional.silu(x)
def _sigmoid(x):
    return torch.sigmoid(x)
def _layernorm(x, axis=-1, eps=1e-5):
    m = x.mean(dim=axis, keepdim=True)
    v = x.var(dim=axis, keepdim=True, unbiased=False)
    return (x - m) / torch.sqrt(v + eps)
def _scatter_add(tgt, idx, src, axis=0):
    return tgt.clone().index_add_(axis, idx, src)
def _segment_sum(src, seg, n):
    out = torch.zeros((n,) + src.shape[1:], dtype=src.dtype)
    return out.index_add_(0, seg, src)
def _pad(x, pw):
    flat = tuple(v for pair in reversed(pw) for v in pair)
    return torch.nn.functional.pad(x, flat)

kernel_name = 'parallel_sum__linear_attn_block__glu_gated_swiglu__prompt'

def setup_inputs():

    _w = (lambda a: (lambda t: t.to(torch.bfloat16) if t.is_floating_point() else t)(torch.as_tensor(a)))
    def _A_setup():
        B, S, D = 1, 2048, 512
        return {
            "x": _w((lambda *s: torch.randn(*s, dtype=torch.bfloat16) * 0.05)(B, S, D)),
            "wqkv": _w((lambda *s: torch.randn(*s, dtype=torch.bfloat16) * 0.05)(D, 3 * D)),
            "wo": _w((lambda *s: torch.randn(*s, dtype=torch.bfloat16) * 0.05)(D, D)),
        }
    _A_in = _A_setup()

    def _B_setup():
        B, S, D, F = 1, 2048, 512, 1792
        return {
            "x": _w((lambda *s: torch.randn(*s, dtype=torch.bfloat16) * 0.05)(B, S, D)),
            "w1": _w((lambda *s: torch.randn(*s, dtype=torch.bfloat16) * 0.2)(D, F) * (2.0 / D) ** 0.5),
            "w3": _w((lambda *s: torch.randn(*s, dtype=torch.bfloat16) * 0.2)(D, F) * (2.0 / D) ** 0.5),
            "w2": _w((lambda *s: torch.randn(*s, dtype=torch.bfloat16) * 0.2)(F, D) * (2.0 / F) ** 0.5),
        }
    _B_in = _B_setup()

    return {
        "A_x": _A_in["x"],
        "A_wqkv": _A_in["wqkv"],
        "A_wo": _A_in["wo"],
        "B_x": _B_in["x"],
        "B_w1": _B_in["w1"],
        "B_w3": _B_in["w3"],
        "B_w2": _B_in["w2"],
    }

def reference(A_x, A_wqkv, A_wo, B_x, B_w1, B_w3, B_w2):
    def _A_ref(x, wqkv, wo):
        B, S, D = x.shape
        H = 32; Dh = D // H
        qkv = (lambda x, *d: x.permute(*d))((x @ wqkv).reshape(B, S, 3, H, Dh), 2, 0, 3, 1, 4)
        q, k, v = qkv[0], qkv[1], qkv[2]
        phi = lambda t: torch.where(t > 0, t + 1, torch.exp(t)) + 1e-6
        pq, pk = phi(q), phi(k)
        kv = torch.einsum("bhsd,bhse->bhde", pk, v)
        z = torch.einsum("bhsd->bhd", pk)
        num = torch.einsum("bhqd,bhde->bhqe", pq, kv)
        den = torch.einsum("bhqd,bhd->bhq", pq, z)[..., None] + 1e-6
        o = num / den
        return (lambda x, *d: x.permute(*d))(o, 0, 2, 1, 3).reshape(B, S, D) @ wo

    def _B_ref(x, w1, w3, w2):
        gate = torch.einsum("bsd,df->bsf", x, w1)
        up = torch.einsum("bsd,df->bsf", x, w3)
        h = _silu(gate) * up
        out = torch.einsum("bsf,fd->bsd", h, w2)
        return out

    x = A_x
    xn = _layernorm(x, axis=-1)
    return x + _A_ref(xn, A_wqkv, A_wo) + _B_ref(xn, B_w1, B_w3, B_w2)
```

```asm
; @launch grid=(256,1,1) block=(512,1,1) lds=163840
.amdgcn_target "amdgcn-amd-amdhsa--gfx950"
.text
.globl parallel_sum__linear_attn_block__glu_gated_swiglu__prompt_kernel
.p2align 8
.type parallel_sum__linear_attn_block__glu_gated_swiglu__prompt_kernel,@function
parallel_sum__linear_attn_block__glu_gated_swiglu__prompt_kernel:
s_load_dwordx16 s[4:19], s[0:1], 0
s_load_dwordx4 s[20:23], s[0:1], 64
s_cmp_ge_u32 s2, 256
s_cbranch_scc1 L_end
v_lshrrev_b32 v1, 6, v0
v_and_b32 v0, 63, v0
v_readfirstlane_b32 s24, v1
s_getpc_b64 s[28:29]
L_pcref:
v_lshlrev_b32 v1, 6, v1
v_add_u32 v1, v1, v0
v_lshlrev_b32 v1, 7, v1
v_min_u32 v1, L_end-L_pcref, v1
global_load_dword v31, v1, s[28:29]
s_bfe_u32 s25, s2, 0x10002
s_lshl_b32 s25, s25, 2
s_lshr_b32 s44, s2, 6
s_add_u32 s25, s25, s44
s_and_b32 s38, s24, 3
s_cmp_lt_u32 s24, 4
s_cbranch_scc1 L_compute
v_lshrrev_b32 v112, 3, v0
v_lshlrev_b32 v112, 10, v112
v_lshrrev_b32 v113, 4, v0
v_and_b32 v114, 7, v0
v_xor_b32 v114, v114, v113
v_lshl_add_u32 v2, v114, 4, v112
v_xor_b32 v114, 4, v114
v_lshl_add_u32 v3, v114, 4, v112
s_lshl_b32 s50, s25, 18
s_lshl_b32 s44, s38, 16
s_add_u32 s50, s50, s44
s_lshl_b32 s48, s38, 13
s_waitcnt lgkmcnt(0)
s_mov_b32 s40, s4
s_mov_b32 s41, s5
s_mov_b32 s42, 0x200000
s_mov_b32 s43, 0x00020000
s_add_u32 m0, s48, 0
s_add_u32 s44, s50, 0
buffer_load_dwordx4 v2, s[40:43], s44 offen lds
s_add_u32 m0, s48, 1024
s_add_u32 s44, s50, 8192
buffer_load_dwordx4 v3, s[40:43], s44 offen lds
s_add_u32 m0, s48, 2048
s_add_u32 s44, s50, 16384
buffer_load_dwordx4 v2, s[40:43], s44 offen lds
s_add_u32 m0, s48, 3072
s_add_u32 s44, s50, 24576
buffer_load_dwordx4 v3, s[40:43], s44 offen lds
s_add_u32 m0, s48, 4096
s_add_u32 s44, s50, 32768
buffer_load_dwordx4 v2, s[40:43], s44 offen lds
s_add_u32 m0, s48, 5120
s_add_u32 s44, s50, 40960
buffer_load_dwordx4 v3, s[40:43], s44 offen lds
s_add_u32 m0, s48, 6144
s_add_u32 s44, s50, 49152
buffer_load_dwordx4 v2, s[40:43], s44 offen lds
s_add_u32 m0, s48, 7168
s_add_u32 s44, s50, 57344
buffer_load_dwordx4 v3, s[40:43], s44 offen lds
s_and_b32 s44, s2, 3
s_bfe_u32 s45, s2, 0x30003
s_lshl_b32 s76, s44, 3
s_add_u32 s76, s76, s45
s_lshl_b32 s78, s44, 1
s_lshr_b32 s46, s45, 2
s_add_u32 s78, s78, s46
s_add_u32 s78, s78, 1
s_and_b32 s46, s45, 3
s_cmp_eq_u32 s46, 0
s_cselect_b32 s78, s78, 0
s_lshl_b32 s27, s44, 2
s_add_u32 s27, s27, s45
s_lshl_b32 s46, s44, 1
s_and_b32 s47, s45, 1
s_add_u32 s46, s46, s47
s_lshr_b32 s26, s45, 1
s_sub_u32 s26, s26, 1
s_max_i32 s26, s26, 0
s_cmp_ge_u32 s45, 4
s_cselect_b32 s27, s46, s27
s_and_b32 s47, s38, 1
s_cmp_eq_u32 s26, 1
s_cbranch_scc1 L_ld_b1
s_lshl_b32 s44, s27, 7
s_mul_i32 s45, s27, 160
s_add_u32 s45, s45, 2048
s_cmp_eq_u32 s26, 2
s_cselect_b32 s44, s45, s44
s_add_u32 s56, s12, s44
s_addc_u32 s57, s13, 0
s_sub_u32 s58, 1835008, s44
s_mov_b32 s59, 0x00020000
s_add_u32 s60, s14, s44
s_addc_u32 s61, s15, 0
s_sub_u32 s62, 1835008, s44
s_mov_b32 s63, 0x00020000
s_movk_i32 s36, 3584
s_cmp_eq_u32 s26, 2
s_cbranch_scc1 L_ld_b2
s_lshl_b32 s44, s27, 6
s_lshl_b32 s45, s47, 5
s_add_u32 s44, s44, s45
s_add_u32 s68, s6, s44
s_addc_u32 s69, s7, 0
s_sub_u32 s70, 1572864, s44
s_mov_b32 s71, 0x00020000
s_movk_i32 s37, 3072
s_branch L_ld_go
L_ld_b2:
s_add_u32 s44, s44, 128
s_branch L_ld_fq
L_ld_b1:
s_lshl_b32 s44, s27, 7
s_add_u32 s44, s44, 1024
s_add_u32 s56, s6, s44
s_addc_u32 s57, s7, 0
s_sub_u32 s58, 1572864, s44
s_mov_b32 s59, 0x00020000
s_add_u32 s44, s44, 1024
s_add_u32 s60, s6, s44
s_addc_u32 s61, s7, 0
s_sub_u32 s62, 1572864, s44
s_mov_b32 s63, 0x00020000
s_movk_i32 s36, 3072
s_lshl_b32 s44, s27, 5
s_add_u32 s44, s44, 3328
L_ld_fq:
s_cmp_eq_u32 s47, 0
s_cselect_b32 s45, s12, s14
s_cselect_b32 s46, s13, s15
s_add_u32 s68, s45, s44
s_addc_u32 s69, s46, 0
s_sub_u32 s70, 1835008, s44
s_mov_b32 s71, 0x00020000
s_movk_i32 s37, 3584
L_ld_go:
v_lshrrev_b32 v112, 3, v0
v_mul_u32_u24 v112, s36, v112
v_bfe_u32 v113, v0, 4, 1
v_lshlrev_b32 v113, 2, v113
v_and_b32 v114, 7, v0
v_xor_b32 v114, v114, v113
v_lshl_add_u32 v4, v114, 4, v112
v_xor_b32 v114, 2, v114
v_lshl_add_u32 v5, v114, 4, v112
s_lshl_b32 s45, s47, 2
v_lshrrev_b32 v112, 1, v0
v_xor_b32 v112, s45, v112
v_mul_u32_u24 v112, s37, v112
v_and_b32 v113, 1, v0
v_lshl_add_u32 v6, v113, 4, v112
s_lshl_b32 s72, s36, 6
s_lshl_b32 s73, s37, 6
s_lshl_b32 s44, s38, 4
s_mul_i32 s74, s44, s36
s_lshr_b32 s44, s38, 1
s_lshl_b32 s44, s44, 5
s_mul_i32 s75, s44, s37
s_lshl_b32 s51, s36, 3
s_lshl_b32 s49, s38, 11
s_add_u32 s49, s49, 32768
s_lshl_b32 s52, s47, 11
s_lshr_b32 s44, s38, 1
s_lshl_b32 s44, s44, 10
s_add_u32 s52, s52, s44
s_add_u32 s52, s52, 49152
s_add_u32 m0, s49, 0
s_nop 0
buffer_load_dwordx4 v4, s[56:59], s74 offen lds
s_add_u32 m0, s49, 1024
s_add_u32 s44, s74, s51
buffer_load_dwordx4 v4, s[56:59], s44 offen lds
s_add_u32 m0, s49, 8192
s_nop 0
buffer_load_dwordx4 v5, s[60:63], s74 offen lds
s_add_u32 m0, s49, 9216
s_add_u32 s44, s74, s51
buffer_load_dwordx4 v5, s[60:63], s44 offen lds
s_add_u32 m0, s52, 0
s_add_u32 s74, s74, s72
buffer_load_dwordx4 v6, s[68:71], s75 offen lds
s_add_u32 s75, s75, s73
s_add_u32 m0, s49, 53248
s_nop 0
buffer_load_dwordx4 v4, s[56:59], s74 offen lds
s_add_u32 m0, s49, 54272
s_add_u32 s44, s74, s51
buffer_load_dwordx4 v4, s[56:59], s44 offen lds
s_add_u32 m0, s49, 61440
s_nop 0
buffer_load_dwordx4 v5, s[60:63], s74 offen lds
s_add_u32 m0, s49, 62464
s_add_u32 s44, s74, s51
buffer_load_dwordx4 v5, s[60:63], s44 offen lds
s_add_u32 m0, s52, 53248
s_add_u32 s74, s74, s72
buffer_load_dwordx4 v6, s[68:71], s75 offen lds
s_add_u32 s75, s75, s73
s_and_b32 s37, s2, 7
s_bfe_u32 s36, s2, 0x30003
s_lshr_b32 s44, s2, 6
s_lshl_b32 s39, s37, 2
s_add_u32 s39, s39, s44
s_mov_b32 s28, s16
s_mov_b32 s29, s17
s_mov_b32 s30, 1835008
s_mov_b32 s31, 0x00020000
s_mov_b32 s32, s8
s_mov_b32 s33, s9
s_mov_b32 s34, 524288
s_mov_b32 s35, 0x00020000
v_lshlrev_b32 v20, 10, v0
s_lshl_b32 s44, s36, 7
v_add_u32 v20, s44, v20
s_waitcnt vmcnt(5)
s_barrier
s_add_u32 m0, s48, 106496
s_add_u32 s44, s50, 256
buffer_load_dwordx4 v2, s[40:43], s44 offen lds
s_add_u32 m0, s48, 107520
s_add_u32 s44, s50, 8448
buffer_load_dwordx4 v3, s[40:43], s44 offen lds
s_add_u32 m0, s48, 108544
s_add_u32 s44, s50, 16640
buffer_load_dwordx4 v2, s[40:43], s44 offen lds
s_add_u32 m0, s48, 109568
s_add_u32 s44, s50, 24832
buffer_load_dwordx4 v3, s[40:43], s44 offen lds
s_add_u32 m0, s48, 110592
s_add_u32 s44, s50, 33024
buffer_load_dwordx4 v2, s[40:43], s44 offen lds
s_add_u32 m0, s48, 111616
s_add_u32 s44, s50, 41216
buffer_load_dwordx4 v3, s[40:43], s44 offen lds
s_add_u32 m0, s48, 112640
s_add_u32 s44, s50, 49408
buffer_load_dwordx4 v2, s[40:43], s44 offen lds
s_add_u32 m0, s48, 113664
s_add_u32 s44, s50, 57600
buffer_load_dwordx4 v3, s[40:43], s44 offen lds
s_add_u32 m0, s49, 106496
s_nop 0
buffer_load_dwordx4 v4, s[56:59], s74 offen lds
s_add_u32 m0, s49, 107520
s_add_u32 s44, s74, s51
buffer_load_dwordx4 v4, s[56:59], s44 offen lds
s_add_u32 m0, s49, 114688
s_nop 0
buffer_load_dwordx4 v5, s[60:63], s74 offen lds
s_add_u32 m0, s49, 115712
s_add_u32 s44, s74, s51
buffer_load_dwordx4 v5, s[60:63], s44 offen lds
s_add_u32 m0, s52, 106496
s_add_u32 s74, s74, s72
buffer_load_dwordx4 v6, s[68:71], s75 offen lds
s_add_u32 s75, s75, s73
s_mul_i32 s44, s38, 18
v_add_u32 v116, s44, v0
v_lshrrev_b32 v112, 3, v116
s_mul_i32 s44, s2, 9
v_add_u32 v112, s44, v112
v_cmp_le_u32 vcc, 1792, v112
v_mov_b32 v114, s16
v_mov_b32 v118, s8
v_cndmask_b32 v114, v114, v118, vcc
v_mov_b32 v115, s17
v_mov_b32 v118, s9
v_cndmask_b32 v115, v115, v118, vcc
v_subrev_u32 v118, 1792, v112
v_cndmask_b32 v112, v112, v118, vcc
v_lshlrev_b32 v112, 10, v112
v_and_b32 v118, 7, v116
v_lshl_add_u32 v112, v118, 7, v112
v_add_co_u32 v114, vcc, v114, v112
s_nop 1
v_addc_co_u32 v115, vcc, 0, v115, vcc
s_mov_b64 s[64:65], exec
s_mov_b64 exec, 0x3ffff
global_load_dword v21, v[114:115], off
s_mov_b64 exec, s[64:65]
s_waitcnt vmcnt(14)
s_barrier
s_cmp_lg_u32 s2, 0
s_cbranch_scc1 L_nogate
s_cmp_lg_u32 s38, 0
s_cbranch_scc1 L_nogate
v_mov_b32 v112, 0
v_mov_b32 v113, 1
s_mov_b64 s[64:65], exec
s_mov_b64 exec, 1
global_store_dword v112, v113, s[20:21] sc1
s_mov_b64 exec, s[64:65]
L_nogate:
s_cmp_lg_u32 s38, 0
s_cbranch_scc1 L_nors
s_cmp_eq_u32 s78, 0
s_cbranch_scc1 L_nors
s_lshl_b32 s44, s25, 2
s_add_u32 s44, s44, 8
v_mov_b32 v112, s44
v_mov_b32 v113, 1
s_mov_b64 s[64:65], exec
s_mov_b64 exec, 1
global_atomic_add v112, v113, s[20:21]
s_mov_b64 exec, s[64:65]
L_nors:
s_add_u32 m0, s48, 0
s_add_u32 s44, s50, 384
buffer_load_dwordx4 v2, s[40:43], s44 offen lds
s_add_u32 m0, s48, 1024
s_add_u32 s44, s50, 8576
buffer_load_dwordx4 v3, s[40:43], s44 offen lds
s_add_u32 m0, s48, 2048
s_add_u32 s44, s50, 16768
buffer_load_dwordx4 v2, s[40:43], s44 offen lds
s_add_u32 m0, s48, 3072
s_add_u32 s44, s50, 24960
buffer_load_dwordx4 v3, s[40:43], s44 offen lds
s_add_u32 m0, s48, 4096
s_add_u32 s44, s50, 33152
buffer_load_dwordx4 v2, s[40:43], s44 offen lds
s_add_u32 m0, s48, 5120
s_add_u32 s44, s50, 41344
buffer_load_dwordx4 v3, s[40:43], s44 offen lds
s_add_u32 m0, s48, 6144
s_add_u32 s44, s50, 49536
buffer_load_dwordx4 v2, s[40:43], s44 offen lds
s_add_u32 m0, s48, 7168
s_add_u32 s44, s50, 57728
buffer_load_dwordx4 v3, s[40:43], s44 offen lds
s_add_u32 m0, s49, 0
s_nop 0
buffer_load_dwordx4 v4, s[56:59], s74 offen lds
s_add_u32 m0, s49, 1024
s_add_u32 s44, s74, s51
buffer_load_dwordx4 v4, s[56:59], s44 offen lds
s_add_u32 m0, s49, 8192
s_nop 0
buffer_load_dwordx4 v5, s[60:63], s74 offen lds
s_add_u32 m0, s49, 9216
s_add_u32 s44, s74, s51
buffer_load_dwordx4 v5, s[60:63], s44 offen lds
s_add_u32 m0, s52, 0
s_add_u32 s74, s74, s72
buffer_load_dwordx4 v6, s[68:71], s75 offen lds
s_add_u32 s75, s75, s73
s_waitcnt vmcnt(14)
s_barrier
s_add_u32 m0, s48, 53248
s_add_u32 s44, s50, 512
buffer_load_dwordx4 v2, s[40:43], s44 offen lds
s_add_u32 m0, s48, 54272
s_add_u32 s44, s50, 8704
buffer_load_dwordx4 v3, s[40:43], s44 offen lds
s_add_u32 m0, s48, 55296
s_add_u32 s44, s50, 16896
buffer_load_dwordx4 v2, s[40:43], s44 offen lds
s_add_u32 m0, s48, 56320
s_add_u32 s44, s50, 25088
buffer_load_dwordx4 v3, s[40:43], s44 offen lds
s_add_u32 m0, s48, 57344
s_add_u32 s44, s50, 33280
buffer_load_dwordx4 v2, s[40:43], s44 offen lds
s_add_u32 m0, s48, 58368
s_add_u32 s44, s50, 41472
buffer_load_dwordx4 v3, s[40:43], s44 offen lds
s_add_u32 m0, s48, 59392
s_add_u32 s44, s50, 49664
buffer_load_dwordx4 v2, s[40:43], s44 offen lds
s_add_u32 m0, s48, 60416
s_add_u32 s44, s50, 57856
buffer_load_dwordx4 v3, s[40:43], s44 offen lds
s_add_u32 m0, s49, 53248
s_nop 0
buffer_load_dwordx4 v4, s[56:59], s74 offen lds
s_add_u32 m0, s49, 54272
s_add_u32 s44, s74, s51
buffer_load_dwordx4 v4, s[56:59], s44 offen lds
s_add_u32 m0, s49, 61440
s_nop 0
buffer_load_dwordx4 v5, s[60:63], s74 offen lds
s_add_u32 m0, s49, 62464
s_add_u32 s44, s74, s51
buffer_load_dwordx4 v5, s[60:63], s44 offen lds
s_add_u32 m0, s52, 53248
s_add_u32 s74, s74, s72
buffer_load_dwordx4 v6, s[68:71], s75 offen lds
s_add_u32 s75, s75, s73
s_waitcnt vmcnt(13)
s_barrier
s_add_u32 m0, s48, 106496
s_add_u32 s44, s50, 640
buffer_load_dwordx4 v2, s[40:43], s44 offen lds
s_add_u32 m0, s48, 107520
s_add_u32 s44, s50, 8832
buffer_load_dwordx4 v3, s[40:43], s44 offen lds
s_add_u32 m0, s48, 108544
s_add_u32 s44, s50, 17024
buffer_load_dwordx4 v2, s[40:43], s44 offen lds
s_add_u32 m0, s48, 109568
s_add_u32 s44, s50, 25216
buffer_load_dwordx4 v3, s[40:43], s44 offen lds
s_add_u32 m0, s48, 110592
s_add_u32 s44, s50, 33408
buffer_load_dwordx4 v2, s[40:43], s44 offen lds
s_add_u32 m0, s48, 111616
s_add_u32 s44, s50, 41600
buffer_load_dwordx4 v3, s[40:43], s44 offen lds
s_add_u32 m0, s48, 112640
s_add_u32 s44, s50, 49792
buffer_load_dwordx4 v2, s[40:43], s44 offen lds
s_add_u32 m0, s48, 113664
s_add_u32 s44, s50, 57984
buffer_load_dwordx4 v3, s[40:43], s44 offen lds
s_add_u32 m0, s49, 106496
s_nop 0
buffer_load_dwordx4 v4, s[56:59], s74 offen lds
s_add_u32 m0, s49, 107520
s_add_u32 s44, s74, s51
buffer_load_dwordx4 v4, s[56:59], s44 offen lds
s_add_u32 m0, s49, 114688
s_nop 0
buffer_load_dwordx4 v5, s[60:63], s74 offen lds
s_add_u32 m0, s49, 115712
s_add_u32 s44, s74, s51
buffer_load_dwordx4 v5, s[60:63], s44 offen lds
s_add_u32 m0, s52, 106496
s_add_u32 s74, s74, s72
buffer_load_dwordx4 v6, s[68:71], s75 offen lds
s_add_u32 s75, s75, s73
s_waitcnt vmcnt(13)
s_barrier
s_add_u32 m0, s48, 0
s_add_u32 s44, s50, 768
buffer_load_dwordx4 v2, s[40:43], s44 offen lds
s_add_u32 m0, s48, 1024
s_add_u32 s44, s50, 8960
buffer_load_dwordx4 v3, s[40:43], s44 offen lds
s_add_u32 m0, s48, 2048
s_add_u32 s44, s50, 17152
buffer_load_dwordx4 v2, s[40:43], s44 offen lds
s_add_u32 m0, s48, 3072
s_add_u32 s44, s50, 25344
buffer_load_dwordx4 v3, s[40:43], s44 offen lds
s_add_u32 m0, s48, 4096
s_add_u32 s44, s50, 33536
buffer_load_dwordx4 v2, s[40:43], s44 offen lds
s_add_u32 m0, s48, 5120
s_add_u32 s44, s50, 41728
buffer_load_dwordx4 v3, s[40:43], s44 offen lds
s_add_u32 m0, s48, 6144
s_add_u32 s44, s50, 49920
buffer_load_dwordx4 v2, s[40:43], s44 offen lds
s_add_u32 m0, s48, 7168
s_add_u32 s44, s50, 58112
buffer_load_dwordx4 v3, s[40:43], s44 offen lds
s_add_u32 m0, s49, 0
s_nop 0
buffer_load_dwordx4 v4, s[56:59], s74 offen lds
s_add_u32 m0, s49, 1024
s_add_u32 s44, s74, s51
buffer_load_dwordx4 v4, s[56:59], s44 offen lds
s_add_u32 m0, s49, 8192
s_nop 0
buffer_load_dwordx4 v5, s[60:63], s74 offen lds
s_add_u32 m0, s49, 9216
s_add_u32 s44, s74, s51
buffer_load_dwordx4 v5, s[60:63], s44 offen lds
s_add_u32 m0, s52, 0
s_add_u32 s74, s74, s72
buffer_load_dwordx4 v6, s[68:71], s75 offen lds
s_add_u32 s75, s75, s73
s_waitcnt vmcnt(13)
s_barrier
s_add_u32 m0, s48, 53248
s_add_u32 s44, s50, 896
buffer_load_dwordx4 v2, s[40:43], s44 offen lds
s_add_u32 m0, s48, 54272
s_add_u32 s44, s50, 9088
buffer_load_dwordx4 v3, s[40:43], s44 offen lds
s_add_u32 m0, s48, 55296
s_add_u32 s44, s50, 17280
buffer_load_dwordx4 v2, s[40:43], s44 offen lds
s_add_u32 m0, s48, 56320
s_add_u32 s44, s50, 25472
buffer_load_dwordx4 v3, s[40:43], s44 offen lds
s_add_u32 m0, s48, 57344
s_add_u32 s44, s50, 33664
buffer_load_dwordx4 v2, s[40:43], s44 offen lds
s_add_u32 m0, s48, 58368
s_add_u32 s44, s50, 41856
buffer_load_dwordx4 v3, s[40:43], s44 offen lds
s_add_u32 m0, s48, 59392
s_add_u32 s44, s50, 50048
buffer_load_dwordx4 v2, s[40:43], s44 offen lds
s_add_u32 m0, s48, 60416
s_add_u32 s44, s50, 58240
buffer_load_dwordx4 v3, s[40:43], s44 offen lds
s_add_u32 m0, s49, 53248
s_nop 0
buffer_load_dwordx4 v4, s[56:59], s74 offen lds
s_add_u32 m0, s49, 54272
s_add_u32 s44, s74, s51
buffer_load_dwordx4 v4, s[56:59], s44 offen lds
s_add_u32 m0, s49, 61440
s_nop 0
buffer_load_dwordx4 v5, s[60:63], s74 offen lds
s_add_u32 m0, s49, 62464
s_add_u32 s44, s74, s51
buffer_load_dwordx4 v5, s[60:63], s44 offen lds
s_add_u32 m0, s52, 53248
s_add_u32 s74, s74, s72
buffer_load_dwordx4 v6, s[68:71], s75 offen lds
s_add_u32 s75, s75, s73
s_waitcnt vmcnt(13)
s_barrier
s_cmp_eq_u32 s38, 1
s_cbranch_scc1 L_rs_fetch
s_cmp_lg_u32 s38, 0
s_cbranch_scc1 L_rs_done
v_mov_b32 v112, 0
s_mov_b32 s46, 0
L_poll_gate:
global_load_dword v113, v112, s[20:21] sc1
s_waitcnt vmcnt(0)
v_readfirstlane_b32 s47, v113
s_add_u32 s46, s46, 1
s_nop 2
s_cmp_ge_u32 s47, 1
s_cbranch_scc1 L_pollok_gate
s_cmp_lt_u32 s46, 400000
s_cbranch_scc1 L_poll_gate
L_pollok_gate:
s_branch L_rs_done
L_rs_fetch:
s_lshl_b32 s45, s25, 2
s_add_u32 s45, s45, 8
v_mov_b32 v112, s45
s_mov_b32 s46, 0
L_poll_rs:
global_load_dword v113, v112, s[20:21] sc1
s_waitcnt vmcnt(0)
v_readfirstlane_b32 s47, v113
s_add_u32 s46, s46, 1
s_nop 2
s_cmp_ge_u32 s47, 8
s_cbranch_scc1 L_pollok_rs
s_cmp_lt_u32 s46, 400000
s_cbranch_scc1 L_poll_rs
L_pollok_rs:
s_lshl_b32 s44, s25, 11
s_add_u32 s44, s44, 9568256
s_add_u32 s66, s22, s44
s_addc_u32 s67, s23, 0
v_lshlrev_b32 v112, 4, v0
global_load_dwordx4 v[116:119], v112, s[66:67] sc1
global_load_dwordx4 v[120:123], v112, s[66:67] offset:1024 sc1
v_add_u32 v112, 159744, v112
s_waitcnt vmcnt(0)
ds_write_b128 v112, v[116:119]
ds_write_b128 v112, v[120:123] offset:1024
L_rs_done:
s_nop 1
v_lshrrev_b32 v112, 3, v0
v_lshlrev_b32 v112, 10, v112
v_bfe_u32 v113, v0, 4, 1
v_lshlrev_b32 v113, 2, v113
v_and_b32 v1, 7, v0
v_xor_b32 v1, v1, v113
v_lshl_add_u32 v1, v1, 4, v112
s_add_u32 s51, s38, 4
s_mul_i32 s56, s51, 229376
s_lshl_b32 s44, s36, 7
s_add_u32 s56, s56, s44
s_lshl_b32 s57, s51, 16
s_add_u32 s57, s57, s44
s_mul_i32 s58, s38, 229376
s_lshl_b32 s44, s36, 7
s_add_u32 s58, s58, s44
s_lshl_b32 s59, s38, 16
s_add_u32 s59, s59, s44
s_mul_i32 s60, s38, 12288
s_add_u32 s52, s60, 106496
v_lshrrev_b32 v112, 5, v0
v_lshlrev_b32 v112, 3, v112
v_bfe_u32 v113, v0, 2, 2
v_add_u32 v112, v112, v113
v_lshlrev_b32 v112, 7, v112
v_bfe_u32 v113, v0, 3, 1
v_lshlrev_b32 v113, 2, v113
v_bfe_u32 v114, v0, 4, 1
v_lshl_add_u32 v113, v114, 1, v113
v_bfe_u32 v114, v0, 1, 1
v_add_u32 v113, v113, v114
v_lshl_add_u32 v112, v113, 4, v112
v_and_b32 v113, 1, v0
v_lshl_add_u32 v112, v113, 3, v112
v_add_u32 v2, s52, v112
v_xor_b32 v3, 64, v2
v_lshrrev_b32 v112, 5, v0
v_lshlrev_b32 v112, 3, v112
v_bfe_u32 v113, v0, 2, 2
v_add_u32 v112, v112, v113
v_lshlrev_b32 v112, 7, v112
v_bfe_u32 v113, v0, 3, 1
v_lshlrev_b32 v113, 2, v113
v_bfe_u32 v114, v0, 4, 1
v_lshl_add_u32 v113, v114, 1, v113
v_bfe_u32 v114, v0, 1, 1
v_add_u32 v113, v113, v114
v_lshl_add_u32 v112, v113, 4, v112
v_and_b32 v113, 1, v0
v_lshl_add_u32 v112, v113, 3, v112
v_add_u32 v4, s60, v112
v_xor_b32 v5, 64, v4
s_add_u32 m0, s52, 0
s_add_u32 s44, s56, 0
buffer_load_dwordx4 v1, s[28:31], s44 offen lds
s_add_u32 m0, s52, 1024
s_add_u32 s44, s56, 8192
buffer_load_dwordx4 v1, s[28:31], s44 offen lds
s_add_u32 m0, s52, 2048
s_add_u32 s44, s56, 16384
buffer_load_dwordx4 v1, s[28:31], s44 offen lds
s_add_u32 m0, s52, 3072
s_add_u32 s44, s56, 24576
buffer_load_dwordx4 v1, s[28:31], s44 offen lds
s_add_u32 m0, s52, 4096
s_add_u32 s44, s56, 32768
buffer_load_dwordx4 v1, s[28:31], s44 offen lds
s_add_u32 m0, s52, 5120
s_add_u32 s44, s56, 40960
buffer_load_dwordx4 v1, s[28:31], s44 offen lds
s_add_u32 m0, s52, 6144
s_add_u32 s44, s56, 49152
buffer_load_dwordx4 v1, s[28:31], s44 offen lds
s_add_u32 m0, s52, 7168
s_add_u32 s44, s56, 57344
buffer_load_dwordx4 v1, s[28:31], s44 offen lds
s_add_u32 m0, s52, 8192
s_add_u32 s44, s56, 65536
buffer_load_dwordx4 v1, s[28:31], s44 offen lds
s_add_u32 m0, s52, 9216
s_add_u32 s44, s56, 73728
buffer_load_dwordx4 v1, s[28:31], s44 offen lds
s_add_u32 m0, s52, 10240
s_add_u32 s44, s56, 81920
buffer_load_dwordx4 v1, s[28:31], s44 offen lds
s_add_u32 m0, s52, 11264
s_add_u32 s44, s56, 90112
buffer_load_dwordx4 v1, s[28:31], s44 offen lds
s_waitcnt vmcnt(12)
s_barrier
s_add_u32 m0, s60, 0
s_add_u32 s44, s56, 98304
buffer_load_dwordx4 v1, s[28:31], s44 offen lds
s_add_u32 m0, s60, 1024
s_add_u32 s44, s56, 106496
buffer_load_dwordx4 v1, s[28:31], s44 offen lds
s_add_u32 m0, s60, 2048
s_add_u32 s44, s56, 114688
buffer_load_dwordx4 v1, s[28:31], s44 offen lds
s_add_u32 m0, s60, 3072
s_add_u32 s44, s56, 122880
buffer_load_dwordx4 v1, s[28:31], s44 offen lds
s_add_u32 m0, s60, 4096
s_add_u32 s44, s56, 131072
buffer_load_dwordx4 v1, s[28:31], s44 offen lds
s_add_u32 m0, s60, 5120
s_add_u32 s44, s56, 139264
buffer_load_dwordx4 v1, s[28:31], s44 offen lds
s_add_u32 m0, s60, 6144
s_add_u32 s44, s56, 147456
buffer_load_dwordx4 v1, s[28:31], s44 offen lds
s_add_u32 m0, s60, 7168
s_add_u32 s44, s56, 155648
buffer_load_dwordx4 v1, s[28:31], s44 offen lds
s_add_u32 m0, s60, 8192
s_add_u32 s44, s56, 163840
buffer_load_dwordx4 v1, s[28:31], s44 offen lds
s_add_u32 m0, s60, 9216
s_add_u32 s44, s56, 172032
buffer_load_dwordx4 v1, s[28:31], s44 offen lds
s_add_u32 m0, s60, 10240
s_add_u32 s44, s56, 180224
buffer_load_dwordx4 v1, s[28:31], s44 offen lds
s_add_u32 m0, s60, 11264
s_add_u32 s44, s56, 188416
buffer_load_dwordx4 v1, s[28:31], s44 offen lds
s_waitcnt vmcnt(12)
ds_read_b64_tr_b16 v[48:49], v2 offset:0
ds_read_b64_tr_b16 v[50:51], v2 offset:512
ds_read_b64_tr_b16 v[52:53], v3 offset:0
ds_read_b64_tr_b16 v[54:55], v3 offset:512
ds_read_b64_tr_b16 v[56:57], v2 offset:2048
ds_read_b64_tr_b16 v[58:59], v2 offset:2560
ds_read_b64_tr_b16 v[60:61], v3 offset:2048
ds_read_b64_tr_b16 v[62:63], v3 offset:2560
ds_read_b64_tr_b16 v[64:65], v2 offset:4096
ds_read_b64_tr_b16 v[66:67], v2 offset:4608
ds_read_b64_tr_b16 v[68:69], v3 offset:4096
ds_read_b64_tr_b16 v[70:71], v3 offset:4608
ds_read_b64_tr_b16 v[72:73], v2 offset:6144
ds_read_b64_tr_b16 v[74:75], v2 offset:6656
ds_read_b64_tr_b16 v[76:77], v3 offset:6144
ds_read_b64_tr_b16 v[78:79], v3 offset:6656
ds_read_b64_tr_b16 v[80:81], v2 offset:8192
ds_read_b64_tr_b16 v[82:83], v2 offset:8704
ds_read_b64_tr_b16 v[84:85], v3 offset:8192
ds_read_b64_tr_b16 v[86:87], v3 offset:8704
ds_read_b64_tr_b16 v[88:89], v2 offset:10240
ds_read_b64_tr_b16 v[90:91], v2 offset:10752
ds_read_b64_tr_b16 v[92:93], v3 offset:10240
ds_read_b64_tr_b16 v[94:95], v3 offset:10752
s_waitcnt lgkmcnt(0)
s_add_u32 m0, s52, 0
s_add_u32 s44, s56, 196608
buffer_load_dwordx4 v1, s[28:31], s44 offen lds
s_add_u32 m0, s52, 1024
s_add_u32 s44, s56, 204800
buffer_load_dwordx4 v1, s[28:31], s44 offen lds
s_add_u32 m0, s52, 2048
s_add_u32 s44, s56, 212992
buffer_load_dwordx4 v1, s[28:31], s44 offen lds
s_add_u32 m0, s52, 3072
s_add_u32 s44, s56, 221184
buffer_load_dwordx4 v1, s[28:31], s44 offen lds
s_add_u32 m0, s52, 4096
s_add_u32 s44, s57, 0
buffer_load_dwordx4 v1, s[32:35], s44 offen lds
s_add_u32 m0, s52, 5120
s_add_u32 s44, s57, 8192
buffer_load_dwordx4 v1, s[32:35], s44 offen lds
s_add_u32 m0, s52, 6144
s_add_u32 s44, s57, 16384
buffer_load_dwordx4 v1, s[32:35], s44 offen lds
s_add_u32 m0, s52, 7168
s_add_u32 s44, s57, 24576
buffer_load_dwordx4 v1, s[32:35], s44 offen lds
s_add_u32 m0, s52, 8192
s_add_u32 s44, s57, 32768
buffer_load_dwordx4 v1, s[32:35], s44 offen lds
s_add_u32 m0, s52, 9216
s_add_u32 s44, s57, 40960
buffer_load_dwordx4 v1, s[32:35], s44 offen lds
s_add_u32 m0, s52, 10240
s_add_u32 s44, s57, 49152
buffer_load_dwordx4 v1, s[32:35], s44 offen lds
s_add_u32 m0, s52, 11264
s_add_u32 s44, s57, 57344
buffer_load_dwordx4 v1, s[32:35], s44 offen lds
s_waitcnt lgkmcnt(0)
s_barrier
s_waitcnt vmcnt(12)
ds_read_b64_tr_b16 v[96:97], v4 offset:0
ds_read_b64_tr_b16 v[98:99], v4 offset:512
ds_read_b64_tr_b16 v[100:101], v5 offset:0
ds_read_b64_tr_b16 v[102:103], v5 offset:512
ds_read_b64_tr_b16 v[104:105], v4 offset:2048
ds_read_b64_tr_b16 v[106:107], v4 offset:2560
ds_read_b64_tr_b16 v[108:109], v5 offset:2048
ds_read_b64_tr_b16 v[110:111], v5 offset:2560
ds_read_b64_tr_b16 v[112:113], v4 offset:4096
ds_read_b64_tr_b16 v[114:115], v4 offset:4608
ds_read_b64_tr_b16 v[116:117], v5 offset:4096
ds_read_b64_tr_b16 v[118:119], v5 offset:4608
ds_read_b64_tr_b16 v[120:121], v4 offset:6144
ds_read_b64_tr_b16 v[122:123], v4 offset:6656
ds_read_b64_tr_b16 v[124:125], v5 offset:6144
ds_read_b64_tr_b16 v[126:127], v5 offset:6656
ds_read_b64_tr_b16 v[128:129], v4 offset:8192
ds_read_b64_tr_b16 v[130:131], v4 offset:8704
ds_read_b64_tr_b16 v[132:133], v5 offset:8192
ds_read_b64_tr_b16 v[134:135], v5 offset:8704
ds_read_b64_tr_b16 v[136:137], v4 offset:10240
ds_read_b64_tr_b16 v[138:139], v4 offset:10752
ds_read_b64_tr_b16 v[140:141], v5 offset:10240
ds_read_b64_tr_b16 v[142:143], v5 offset:10752
s_waitcnt lgkmcnt(0)
s_add_u32 m0, s60, 0
s_add_u32 s44, s58, 0
buffer_load_dwordx4 v1, s[28:31], s44 offen lds
s_add_u32 m0, s60, 1024
s_add_u32 s44, s58, 8192
buffer_load_dwordx4 v1, s[28:31], s44 offen lds
s_add_u32 m0, s60, 2048
s_add_u32 s44, s58, 16384
buffer_load_dwordx4 v1, s[28:31], s44 offen lds
s_add_u32 m0, s60, 3072
s_add_u32 s44, s58, 24576
buffer_load_dwordx4 v1, s[28:31], s44 offen lds
s_add_u32 m0, s60, 4096
s_add_u32 s44, s58, 32768
buffer_load_dwordx4 v1, s[28:31], s44 offen lds
s_add_u32 m0, s60, 5120
s_add_u32 s44, s58, 40960
buffer_load_dwordx4 v1, s[28:31], s44 offen lds
s_add_u32 m0, s60, 6144
s_add_u32 s44, s58, 49152
buffer_load_dwordx4 v1, s[28:31], s44 offen lds
s_add_u32 m0, s60, 7168
s_add_u32 s44, s58, 57344
buffer_load_dwordx4 v1, s[28:31], s44 offen lds
s_add_u32 m0, s60, 8192
s_add_u32 s44, s58, 65536
buffer_load_dwordx4 v1, s[28:31], s44 offen lds
s_add_u32 m0, s60, 9216
s_add_u32 s44, s58, 73728
buffer_load_dwordx4 v1, s[28:31], s44 offen lds
s_add_u32 m0, s60, 10240
s_add_u32 s44, s58, 81920
buffer_load_dwordx4 v1, s[28:31], s44 offen lds
s_add_u32 m0, s60, 11264
s_add_u32 s44, s58, 90112
buffer_load_dwordx4 v1, s[28:31], s44 offen lds
s_waitcnt vmcnt(12)
ds_read_b64_tr_b16 v[144:145], v2 offset:0
ds_read_b64_tr_b16 v[146:147], v2 offset:512
ds_read_b64_tr_b16 v[148:149], v3 offset:0
ds_read_b64_tr_b16 v[150:151], v3 offset:512
ds_read_b64_tr_b16 v[152:153], v2 offset:2048
ds_read_b64_tr_b16 v[154:155], v2 offset:2560
ds_read_b64_tr_b16 v[156:157], v3 offset:2048
ds_read_b64_tr_b16 v[158:159], v3 offset:2560
ds_read_b64_tr_b16 v[160:161], v2 offset:4096
ds_read_b64_tr_b16 v[162:163], v2 offset:4608
ds_read_b64_tr_b16 v[164:165], v3 offset:4096
ds_read_b64_tr_b16 v[166:167], v3 offset:4608
ds_read_b64_tr_b16 v[168:169], v2 offset:6144
ds_read_b64_tr_b16 v[170:171], v2 offset:6656
ds_read_b64_tr_b16 v[172:173], v3 offset:6144
ds_read_b64_tr_b16 v[174:175], v3 offset:6656
ds_read_b64_tr_b16 v[176:177], v2 offset:8192
ds_read_b64_tr_b16 v[178:179], v2 offset:8704
ds_read_b64_tr_b16 v[180:181], v3 offset:8192
ds_read_b64_tr_b16 v[182:183], v3 offset:8704
ds_read_b64_tr_b16 v[184:185], v2 offset:10240
ds_read_b64_tr_b16 v[186:187], v2 offset:10752
ds_read_b64_tr_b16 v[188:189], v3 offset:10240
ds_read_b64_tr_b16 v[190:191], v3 offset:10752
s_waitcnt lgkmcnt(0)
s_add_u32 m0, s52, 0
s_add_u32 s44, s58, 98304
buffer_load_dwordx4 v1, s[28:31], s44 offen lds
s_add_u32 m0, s52, 1024
s_add_u32 s44, s58, 106496
buffer_load_dwordx4 v1, s[28:31], s44 offen lds
s_add_u32 m0, s52, 2048
s_add_u32 s44, s58, 114688
buffer_load_dwordx4 v1, s[28:31], s44 offen lds
s_add_u32 m0, s52, 3072
s_add_u32 s44, s58, 122880
buffer_load_dwordx4 v1, s[28:31], s44 offen lds
s_add_u32 m0, s52, 4096
s_add_u32 s44, s58, 131072
buffer_load_dwordx4 v1, s[28:31], s44 offen lds
s_add_u32 m0, s52, 5120
s_add_u32 s44, s58, 139264
buffer_load_dwordx4 v1, s[28:31], s44 offen lds
s_add_u32 m0, s52, 6144
s_add_u32 s44, s58, 147456
buffer_load_dwordx4 v1, s[28:31], s44 offen lds
s_add_u32 m0, s52, 7168
s_add_u32 s44, s58, 155648
buffer_load_dwordx4 v1, s[28:31], s44 offen lds
s_add_u32 m0, s52, 8192
s_add_u32 s44, s58, 163840
buffer_load_dwordx4 v1, s[28:31], s44 offen lds
s_add_u32 m0, s52, 9216
s_add_u32 s44, s58, 172032
buffer_load_dwordx4 v1, s[28:31], s44 offen lds
s_add_u32 m0, s52, 10240
s_add_u32 s44, s58, 180224
buffer_load_dwordx4 v1, s[28:31], s44 offen lds
s_add_u32 m0, s52, 11264
s_add_u32 s44, s58, 188416
buffer_load_dwordx4 v1, s[28:31], s44 offen lds
s_lshl_b32 s44, s39, 16
s_lshl_b32 s45, s36, 7
s_add_u32 s44, s44, s45
s_lshl_b32 s45, s24, 4
s_add_u32 s53, s44, s45
v_and_b32 v9, 31, v0
v_lshlrev_b32 v9, 10, v9
v_lshrrev_b32 v10, 5, v0
v_lshl_add_u32 v9, v10, 3, v9
v_add_u32 v9, s53, v9
global_load_dwordx2 v[44:45], v9, s[4:5]
v_add_u32 v9, 32768, v9
global_load_dwordx2 v[46:47], v9, s[4:5]
s_lshl_b32 s44, s39, 1
s_mul_i32 s45, s44, 112
s_mul_i32 s46, s24, 14
s_add_u32 s45, s45, s46
s_lshl_b32 s45, s45, 10
s_add_u32 s62, s22, s45
s_addc_u32 s63, s23, 0
s_lshl_b32 s45, s44, 5
s_lshl_b32 s46, s24, 2
s_add_u32 s45, s45, s46
s_lshl_b32 s45, s45, 10
s_add_u32 s45, s45, 7340032
s_add_u32 s68, s22, s45
s_addc_u32 s69, s23, 0
s_mov_b32 s61, 0xc0300c0
s_cmp_eq_u32 s24, 5
s_cselect_b32 s61, 0xcc080, s61
s_cmp_eq_u32 s24, 6
s_cselect_b32 s61, 0x43c00000, s61
s_cmp_eq_u32 s24, 7
s_cselect_b32 s61, 0xfc303030, s61
v_lshlrev_b32 v6, 4, v0
v_mov_b32 v7, v6
v_add_u32 v8, 114688, v6
v_mov_b32 v192, 0
v_mov_b32 v193, 0
v_mov_b32 v194, 0
v_mov_b32 v195, 0
v_mov_b32 v196, 0
v_mov_b32 v197, 0
v_mov_b32 v198, 0
v_mov_b32 v199, 0
v_mov_b32 v200, 0
v_mov_b32 v201, 0
v_mov_b32 v202, 0
v_mov_b32 v203, 0
v_mov_b32 v204, 0
v_mov_b32 v205, 0
v_mov_b32 v206, 0
v_mov_b32 v207, 0
v_mov_b32 v208, 0
v_mov_b32 v209, 0
v_mov_b32 v210, 0
v_mov_b32 v211, 0
v_mov_b32 v212, 0
v_mov_b32 v213, 0
v_mov_b32 v214, 0
v_mov_b32 v215, 0
v_mov_b32 v216, 0
v_mov_b32 v217, 0
v_mov_b32 v218, 0
v_mov_b32 v219, 0
v_mov_b32 v220, 0
v_mov_b32 v221, 0
v_mov_b32 v222, 0
v_mov_b32 v223, 0
v_mov_b32 v224, 0
v_mov_b32 v225, 0
v_mov_b32 v226, 0
v_mov_b32 v227, 0
v_mov_b32 v228, 0
v_mov_b32 v229, 0
v_mov_b32 v230, 0
v_mov_b32 v231, 0
v_mov_b32 v232, 0
v_mov_b32 v233, 0
v_mov_b32 v234, 0
v_mov_b32 v235, 0
v_mov_b32 v236, 0
v_mov_b32 v237, 0
v_mov_b32 v238, 0
v_mov_b32 v239, 0
v_mov_b32 v240, 0
v_mov_b32 v241, 0
v_mov_b32 v242, 0
v_mov_b32 v243, 0
v_mov_b32 v244, 0
v_mov_b32 v245, 0
v_mov_b32 v246, 0
v_mov_b32 v247, 0
v_mov_b32 v248, 0
v_mov_b32 v249, 0
v_mov_b32 v250, 0
v_mov_b32 v251, 0
v_mov_b32 v252, 0
v_mov_b32 v253, 0
v_mov_b32 v254, 0
v_mov_b32 v255, 0
s_lshl_b32 s44, s37, 2
s_and_b32 s45, s39, 3
s_add_u32 s44, s44, s45
s_lshl_b32 s44, s44, 7
s_add_u32 s44, s44, 9474048
v_and_b32 v9, 31, v0
v_lshlrev_b32 v9, 2, v9
v_add_u32 v9, s44, v9
s_waitcnt vmcnt(0)
s_barrier
s_branch L_pub
L_compute:
s_and_b32 s44, s2, 3
s_bfe_u32 s45, s2, 0x30003
s_lshl_b32 s76, s44, 3
s_add_u32 s76, s76, s45
s_lshl_b32 s78, s44, 1
s_lshr_b32 s46, s45, 2
s_add_u32 s78, s78, s46
s_add_u32 s78, s78, 1
s_and_b32 s46, s45, 3
s_cmp_eq_u32 s46, 0
s_cselect_b32 s78, s78, 0
s_lshl_b32 s27, s44, 2
s_add_u32 s27, s27, s45
s_lshl_b32 s46, s44, 1
s_and_b32 s47, s45, 1
s_add_u32 s46, s46, s47
s_lshr_b32 s26, s45, 1
s_sub_u32 s26, s26, 1
s_max_i32 s26, s26, 0
s_cmp_ge_u32 s45, 4
s_cselect_b32 s27, s46, s27
s_waitcnt lgkmcnt(0)
s_cmp_eq_u32 s78, 0
s_cbranch_scc1 L_c_nors1
s_lshl_b32 s44, s25, 3
s_add_u32 s44, s44, s78
s_sub_u32 s44, s44, 1
s_lshl_b32 s44, s44, 2
s_add_u32 s53, s44, s38
s_lshl_b32 s45, s53, 13
s_add_u32 s66, s4, s45
s_addc_u32 s67, s5, 0
v_lshrrev_b32 v2, 3, v0
v_lshlrev_b32 v2, 10, v2
v_and_b32 v3, 7, v0
v_lshl_add_u32 v2, v3, 4, v2
global_load_dwordx4 v[40:43], v2, s[66:67] offset:0
global_load_dwordx4 v[44:47], v2, s[66:67] offset:128
global_load_dwordx4 v[48:51], v2, s[66:67] offset:256
global_load_dwordx4 v[52:55], v2, s[66:67] offset:384
global_load_dwordx4 v[56:59], v2, s[66:67] offset:512
global_load_dwordx4 v[60:63], v2, s[66:67] offset:640
global_load_dwordx4 v[64:67], v2, s[66:67] offset:768
global_load_dwordx4 v[68:71], v2, s[66:67] offset:896
L_c_nors1:
v_and_b32 v2, 31, v0
v_lshrrev_b32 v3, 5, v0
v_lshrrev_b32 v4, 1, v2
v_and_b32 v4, 7, v4
v_xor_b32 v4, v4, v3
v_lshlrev_b32 v4, 4, v4
v_lshl_add_u32 v4, v2, 7, v4
s_lshl_b32 s44, s38, 13
v_add_u32 v32, s44, v4
v_xor_b32 v33, 32, v32
v_xor_b32 v34, 64, v32
v_xor_b32 v35, 96, v32
v_mov_b32 v36, 0
v_mov_b32 v37, 0
v_mov_b32 v38, 0
v_mov_b32 v39, 0
s_nop 1
v_mfma_f32_32x32x16_bf16 v[96:111], v[36:39], v[36:39], 0
v_mfma_f32_32x32x16_bf16 v[112:127], v[36:39], v[36:39], 0
v_mfma_f32_32x32x16_bf16 v[128:143], v[36:39], v[36:39], 0
v_mfma_f32_32x32x16_bf16 v[144:159], v[36:39], v[36:39], 0
v_mfma_f32_32x32x16_bf16 v[160:175], v[36:39], v[36:39], 0
v_mfma_f32_32x32x16_bf16 v[176:191], v[36:39], v[36:39], 0
v_mfma_f32_32x32x16_bf16 v[192:207], v[36:39], v[36:39], 0
v_mfma_f32_32x32x16_bf16 v[208:223], v[36:39], v[36:39], 0
v_mfma_f32_32x32x16_bf16 v[224:239], v[36:39], v[36:39], 0
v_mfma_f32_32x32x16_bf16 v[240:255], v[36:39], v[36:39], 0
s_cmp_eq_u32 s78, 0
s_cbranch_scc1 L_c_nors2
v_mov_b32 v8, 0
v_mov_b32 v9, 0
v_mov_b32 v10, 0
v_mov_b32 v11, 0
v_mov_b32 v12, 0x3f803f80
s_waitcnt vmcnt(0)
v_dot2_f32_bf16 v8, v40, v12, v8
v_dot2_f32_bf16 v10, v40, v40, v10
v_dot2_f32_bf16 v9, v41, v12, v9
v_dot2_f32_bf16 v11, v41, v41, v11
v_dot2_f32_bf16 v8, v42, v12, v8
v_dot2_f32_bf16 v10, v42, v42, v10
v_dot2_f32_bf16 v9, v43, v12, v9
v_dot2_f32_bf16 v11, v43, v43, v11
v_dot2_f32_bf16 v8, v44, v12, v8
v_dot2_f32_bf16 v10, v44, v44, v10
v_dot2_f32_bf16 v9, v45, v12, v9
v_dot2_f32_bf16 v11, v45, v45, v11
v_dot2_f32_bf16 v8, v46, v12, v8
v_dot2_f32_bf16 v10, v46, v46, v10
v_dot2_f32_bf16 v9, v47, v12, v9
v_dot2_f32_bf16 v11, v47, v47, v11
v_dot2_f32_bf16 v8, v48, v12, v8
v_dot2_f32_bf16 v10, v48, v48, v10
v_dot2_f32_bf16 v9, v49, v12, v9
v_dot2_f32_bf16 v11, v49, v49, v11
v_dot2_f32_bf16 v8, v50, v12, v8
v_dot2_f32_bf16 v10, v50, v50, v10
v_dot2_f32_bf16 v9, v51, v12, v9
v_dot2_f32_bf16 v11, v51, v51, v11
v_dot2_f32_bf16 v8, v52, v12, v8
v_dot2_f32_bf16 v10, v52, v52, v10
v_dot2_f32_bf16 v9, v53, v12, v9
v_dot2_f32_bf16 v11, v53, v53, v11
v_dot2_f32_bf16 v8, v54, v12, v8
v_dot2_f32_bf16 v10, v54, v54, v10
v_dot2_f32_bf16 v9, v55, v12, v9
v_dot2_f32_bf16 v11, v55, v55, v11
v_dot2_f32_bf16 v8, v56, v12, v8
v_dot2_f32_bf16 v10, v56, v56, v10
v_dot2_f32_bf16 v9, v57, v12, v9
v_dot2_f32_bf16 v11, v57, v57, v11
v_dot2_f32_bf16 v8, v58, v12, v8
v_dot2_f32_bf16 v10, v58, v58, v10
v_dot2_f32_bf16 v9, v59, v12, v9
v_dot2_f32_bf16 v11, v59, v59, v11
v_dot2_f32_bf16 v8, v60, v12, v8
v_dot2_f32_bf16 v10, v60, v60, v10
v_dot2_f32_bf16 v9, v61, v12, v9
v_dot2_f32_bf16 v11, v61, v61, v11
v_dot2_f32_bf16 v8, v62, v12, v8
v_dot2_f32_bf16 v10, v62, v62, v10
v_dot2_f32_bf16 v9, v63, v12, v9
v_dot2_f32_bf16 v11, v63, v63, v11
v_dot2_f32_bf16 v8, v64, v12, v8
v_dot2_f32_bf16 v10, v64, v64, v10
v_dot2_f32_bf16 v9, v65, v12, v9
v_dot2_f32_bf16 v11, v65, v65, v11
v_dot2_f32_bf16 v8, v66, v12, v8
v_dot2_f32_bf16 v10, v66, v66, v10
v_dot2_f32_bf16 v9, v67, v12, v9
v_dot2_f32_bf16 v11, v67, v67, v11
v_dot2_f32_bf16 v8, v68, v12, v8
v_dot2_f32_bf16 v10, v68, v68, v10
v_dot2_f32_bf16 v9, v69, v12, v9
v_dot2_f32_bf16 v11, v69, v69, v11
v_dot2_f32_bf16 v8, v70, v12, v8
v_dot2_f32_bf16 v10, v70, v70, v10
v_dot2_f32_bf16 v9, v71, v12, v9
v_dot2_f32_bf16 v11, v71, v71, v11
s_nop 1
v_add_f32 v8, v8, v9
v_add_f32 v10, v10, v11
s_nop 0
v_add_f32_dpp v8, v8, v8 quad_perm:[1,0,3,2] row_mask:0xf bank_mask:0xf
v_add_f32_dpp v10, v10, v10 quad_perm:[1,0,3,2] row_mask:0xf bank_mask:0xf
s_nop 0
v_add_f32_dpp v8, v8, v8 quad_perm:[2,3,0,1] row_mask:0xf bank_mask:0xf
v_add_f32_dpp v10, v10, v10 quad_perm:[2,3,0,1] row_mask:0xf bank_mask:0xf
s_nop 0
v_add_f32_dpp v8, v8, v8 row_half_mirror row_mask:0xf bank_mask:0xf
v_add_f32_dpp v10, v10, v10 row_half_mirror row_mask:0xf bank_mask:0xf
s_mov_b32 s46, 0x3b000000
s_mov_b32 s47, 0x3727c5ac
v_mul_f32 v8, s46, v8
v_mul_f32 v10, s46, v10
v_fma_f32 v10, -v8, v8, v10
v_max_f32 v10, 0, v10
v_add_f32 v10, s47, v10
v_rsq_f32 v9, v10
s_lshl_b32 s45, s53, 6
s_add_u32 s45, s45, 9568256
s_add_u32 s66, s22, s45
s_addc_u32 s67, s23, 0
v_and_b32 v10, 7, v0
v_cmp_eq_u32 vcc, 0, v10
v_lshrrev_b32 v10, 3, v0
v_lshlrev_b32 v10, 3, v10
s_nop 1
s_and_saveexec_b64 s[64:65], vcc
global_store_dwordx2 v10, v[8:9], s[66:67] sc1
s_mov_b64 exec, s[64:65]
L_c_nors2:
s_cmp_lg_u32 s2, 0
s_cbranch_scc1 L_nozero
s_add_u32 s66, s22, 9437184
s_addc_u32 s67, s23, 0
v_mov_b32 v4, 0
v_mov_b32 v5, 0
v_mov_b32 v6, 0
v_mov_b32 v7, 0
v_lshlrev_b32 v8, 4, v0
s_mul_i32 s44, s38, 11264
v_add_u32 v8, s44, v8
global_store_dwordx4 v8, v[4:7], s[66:67] offset:0 sc1
global_store_dwordx4 v8, v[4:7], s[66:67] offset:1024 sc1
global_store_dwordx4 v8, v[4:7], s[66:67] offset:2048 sc1
global_store_dwordx4 v8, v[4:7], s[66:67] offset:3072 sc1
s_nop 1
v_add_u32 v8, 4096, v8
global_store_dwordx4 v8, v[4:7], s[66:67] offset:0 sc1
global_store_dwordx4 v8, v[4:7], s[66:67] offset:1024 sc1
global_store_dwordx4 v8, v[4:7], s[66:67] offset:2048 sc1
global_store_dwordx4 v8, v[4:7], s[66:67] offset:3072 sc1
s_nop 1
v_add_u32 v8, 4096, v8
global_store_dwordx4 v8, v[4:7], s[66:67] offset:0 sc1
global_store_dwordx4 v8, v[4:7], s[66:67] offset:1024 sc1
global_store_dwordx4 v8, v[4:7], s[66:67] offset:2048 sc1
L_nozero:
s_mov_b32 s40, s4
s_mov_b32 s41, s5
s_mov_b32 s42, 0x200000
s_mov_b32 s43, 0x00020000
v_lshrrev_b32 v14, 3, v0
v_lshlrev_b32 v14, 10, v14
v_lshrrev_b32 v15, 4, v0
v_and_b32 v16, 7, v0
v_xor_b32 v16, v16, v15
v_lshl_add_u32 v17, v16, 4, v14
v_xor_b32 v16, 4, v16
v_lshl_add_u32 v18, v16, 4, v14
s_lshl_b32 s50, s25, 18
s_lshl_b32 s44, s38, 16
s_add_u32 s50, s50, s44
s_lshl_b32 s48, s38, 13
s_add_u32 m0, s48, 53248
s_add_u32 s44, s50, 128
buffer_load_dwordx4 v17, s[40:43], s44 offen lds
s_add_u32 m0, s48, 54272
s_add_u32 s44, s50, 8320
buffer_load_dwordx4 v18, s[40:43], s44 offen lds
s_add_u32 m0, s48, 55296
s_add_u32 s44, s50, 16512
buffer_load_dwordx4 v17, s[40:43], s44 offen lds
s_add_u32 m0, s48, 56320
s_add_u32 s44, s50, 24704
buffer_load_dwordx4 v18, s[40:43], s44 offen lds
s_add_u32 m0, s48, 57344
s_add_u32 s44, s50, 32896
buffer_load_dwordx4 v17, s[40:43], s44 offen lds
s_add_u32 m0, s48, 58368
s_add_u32 s44, s50, 41088
buffer_load_dwordx4 v18, s[40:43], s44 offen lds
s_add_u32 m0, s48, 59392
s_add_u32 s44, s50, 49280
buffer_load_dwordx4 v17, s[40:43], s44 offen lds
s_add_u32 m0, s48, 60416
s_add_u32 s44, s50, 57472
buffer_load_dwordx4 v18, s[40:43], s44 offen lds
v_bfe_u32 v8, v0, 4, 1
v_lshrrev_b32 v9, 5, v0
v_lshlrev_b32 v9, 3, v9
v_bfe_u32 v10, v0, 2, 2
v_add_u32 v9, v9, v10
v_and_b32 v10, 1, v0
v_lshlrev_b32 v10, 4, v10
v_bfe_u32 v11, v0, 1, 1
v_lshl_add_u32 v10, v11, 3, v10
v_bfe_u32 v11, v0, 3, 1
v_lshlrev_b32 v11, 6, v11
v_lshl_add_u32 v11, v8, 5, v11
v_lshl_add_u32 v12, v9, 7, v10
v_add_u32 v12, v12, v11
v_lshl_add_u32 v12, v8, 13, v12
v_add_u32 v2, 32768, v12
v_xor_b32 v3, 32, v2
v_xor_b32 v4, 64, v2
v_xor_b32 v5, 96, v2
v_lshl_add_u32 v12, v9, 5, v10
v_lshl_add_u32 v12, v8, 11, v12
v_lshl_add_u32 v12, v8, 7, v12
v_add_u32 v6, 49152, v12
v_xor_b32 v7, 128, v6
v_mov_b32 v20, 0
v_mov_b32 v21, 0
v_mov_b32 v22, 0
v_mov_b32 v23, 0
s_mov_b32 s79, 0xffff0000
s_barrier
ds_read_b64_tr_b16 v[48:49], v2 offset:0
ds_read_b64_tr_b16 v[50:51], v2 offset:512
ds_read_b128 v[40:43], v32 offset:0
ds_read_b128 v[44:47], v32 offset:4096
ds_read_b64_tr_b16 v[52:53], v3 offset:0
ds_read_b64_tr_b16 v[54:55], v3 offset:512
ds_read_b64_tr_b16 v[56:57], v4 offset:0
ds_read_b64_tr_b16 v[58:59], v4 offset:512
ds_read_b64_tr_b16 v[60:61], v5 offset:0
ds_read_b64_tr_b16 v[62:63], v5 offset:512
ds_read_b64_tr_b16 v[64:65], v6 offset:0
ds_read_b64_tr_b16 v[66:67], v7 offset:0
s_mov_b32 s55, 0
s_mov_b32 s77, 0
s_cmp_eq_u32 s38, 1
s_cbranch_scc1 L_cloop1
s_cmp_eq_u32 s38, 2
s_cbranch_scc1 L_cloop2
s_cmp_eq_u32 s38, 3
s_cbranch_scc1 L_cloop3
L_cloop0:
s_waitcnt lgkmcnt(0)
v_mfma_f32_32x32x16_bf16 v[96:111], v[48:51], v[40:43], v[96:111]
ds_read_b64_tr_b16 v[76:77], v2 offset:2048
ds_read_b64_tr_b16 v[78:79], v2 offset:2560
v_lshlrev_b32 v24, 16, v48
v_and_b32 v25, s79, v48
v_add_f32 v20, v20, v24
v_mfma_f32_32x32x16_bf16 v[112:127], v[48:51], v[44:47], v[112:127]
ds_read_b128 v[68:71], v33 offset:0
ds_read_b128 v[72:75], v33 offset:4096
v_add_f32 v21, v21, v25
v_lshlrev_b32 v26, 16, v49
v_and_b32 v27, s79, v49
v_mfma_f32_32x32x16_bf16 v[128:143], v[52:55], v[40:43], v[128:143]
ds_read_b64_tr_b16 v[80:81], v3 offset:2048
ds_read_b64_tr_b16 v[82:83], v3 offset:2560
v_add_f32 v20, v20, v26
v_add_f32 v21, v21, v27
v_lshlrev_b32 v28, 16, v50
v_mfma_f32_32x32x16_bf16 v[144:159], v[52:55], v[44:47], v[144:159]
ds_read_b64_tr_b16 v[84:85], v4 offset:2048
ds_read_b64_tr_b16 v[86:87], v4 offset:2560
v_and_b32 v29, s79, v50
v_add_f32 v20, v20, v28
v_add_f32 v21, v21, v29
v_mfma_f32_32x32x16_bf16 v[160:175], v[56:59], v[40:43], v[160:175]
ds_read_b64_tr_b16 v[88:89], v5 offset:2048
ds_read_b64_tr_b16 v[90:91], v5 offset:2560
v_lshlrev_b32 v24, 16, v51
v_and_b32 v25, s79, v51
v_add_f32 v20, v20, v24
v_mfma_f32_32x32x16_bf16 v[176:191], v[56:59], v[44:47], v[176:191]
ds_read_b64_tr_b16 v[92:93], v6 offset:512
ds_read_b64_tr_b16 v[94:95], v7 offset:512
v_add_f32 v21, v21, v25
v_lshlrev_b32 v26, 16, v64
v_and_b32 v27, s79, v64
v_mfma_f32_32x32x16_bf16 v[192:207], v[60:63], v[40:43], v[192:207]
v_add_f32 v22, v22, v26
v_add_f32 v23, v23, v27
v_lshlrev_b32 v28, 16, v65
v_and_b32 v29, s79, v65
v_mfma_f32_32x32x16_bf16 v[208:223], v[60:63], v[44:47], v[208:223]
v_add_f32 v22, v22, v28
v_add_f32 v23, v23, v29
v_lshlrev_b32 v24, 16, v66
v_and_b32 v25, s79, v66
v_add_f32 v22, v22, v24
v_mfma_f32_32x32x16_bf16 v[224:239], v[64:67], v[40:43], v[224:239]
v_add_f32 v23, v23, v25
v_lshlrev_b32 v26, 16, v67
v_and_b32 v27, s79, v67
v_add_f32 v22, v22, v26
v_add_f32 v23, v23, v27
v_mfma_f32_32x32x16_bf16 v[240:255], v[64:67], v[44:47], v[240:255]
s_waitcnt lgkmcnt(0)
v_mfma_f32_32x32x16_bf16 v[96:111], v[76:79], v[68:71], v[96:111]
ds_read_b64_tr_b16 v[48:49], v2 offset:4096
ds_read_b64_tr_b16 v[50:51], v2 offset:4608
v_lshlrev_b32 v24, 16, v76
v_mfma_f32_32x32x16_bf16 v[112:127], v[76:79], v[72:75], v[112:127]
ds_read_b128 v[40:43], v34 offset:0
ds_read_b128 v[44:47], v34 offset:4096
v_and_b32 v25, s79, v76
v_mfma_f32_32x32x16_bf16 v[128:143], v[80:83], v[68:71], v[128:143]
ds_read_b64_tr_b16 v[52:53], v3 offset:4096
ds_read_b64_tr_b16 v[54:55], v3 offset:4608
v_add_f32 v20, v20, v24
v_mfma_f32_32x32x16_bf16 v[144:159], v[80:83], v[72:75], v[144:159]
ds_read_b64_tr_b16 v[56:57], v4 offset:4096
ds_read_b64_tr_b16 v[58:59], v4 offset:4608
v_add_f32 v21, v21, v25
v_mfma_f32_32x32x16_bf16 v[160:175], v[84:87], v[68:71], v[160:175]
ds_read_b64_tr_b16 v[60:61], v5 offset:4096
ds_read_b64_tr_b16 v[62:63], v5 offset:4608
v_lshlrev_b32 v26, 16, v77
v_mfma_f32_32x32x16_bf16 v[176:191], v[84:87], v[72:75], v[176:191]
ds_read_b64_tr_b16 v[64:65], v6 offset:1024
ds_read_b64_tr_b16 v[66:67], v7 offset:1024
v_and_b32 v27, s79, v77
v_add_f32 v20, v20, v26
v_mfma_f32_32x32x16_bf16 v[192:207], v[88:91], v[68:71], v[192:207]
v_add_f32 v21, v21, v27
v_lshlrev_b32 v28, 16, v78
v_and_b32 v29, s79, v78
v_mfma_f32_32x32x16_bf16 v[208:223], v[88:91], v[72:75], v[208:223]
v_add_f32 v20, v20, v28
v_add_f32 v21, v21, v29
v_lshlrev_b32 v24, 16, v79
v_mfma_f32_32x32x16_bf16 v[224:239], v[92:95], v[68:71], v[224:239]
v_and_b32 v25, s79, v79
v_add_f32 v20, v20, v24
v_add_f32 v21, v21, v25
v_mfma_f32_32x32x16_bf16 v[240:255], v[92:95], v[72:75], v[240:255]
s_waitcnt lgkmcnt(0)
v_mfma_f32_32x32x16_bf16 v[96:111], v[48:51], v[40:43], v[96:111]
ds_read_b64_tr_b16 v[76:77], v2 offset:6144
ds_read_b64_tr_b16 v[78:79], v2 offset:6656
v_lshlrev_b32 v24, 16, v48
v_mfma_f32_32x32x16_bf16 v[112:127], v[48:51], v[44:47], v[112:127]
ds_read_b128 v[68:71], v35 offset:0
ds_read_b128 v[72:75], v35 offset:4096
v_and_b32 v25, s79, v48
v_mfma_f32_32x32x16_bf16 v[128:143], v[52:55], v[40:43], v[128:143]
ds_read_b64_tr_b16 v[80:81], v3 offset:6144
ds_read_b64_tr_b16 v[82:83], v3 offset:6656
v_add_f32 v20, v20, v24
v_mfma_f32_32x32x16_bf16 v[144:159], v[52:55], v[44:47], v[144:159]
ds_read_b64_tr_b16 v[84:85], v4 offset:6144
ds_read_b64_tr_b16 v[86:87], v4 offset:6656
v_add_f32 v21, v21, v25
v_mfma_f32_32x32x16_bf16 v[160:175], v[56:59], v[40:43], v[160:175]
ds_read_b64_tr_b16 v[88:89], v5 offset:6144
ds_read_b64_tr_b16 v[90:91], v5 offset:6656
v_lshlrev_b32 v26, 16, v49
v_mfma_f32_32x32x16_bf16 v[176:191], v[56:59], v[44:47], v[176:191]
ds_read_b64_tr_b16 v[92:93], v6 offset:1536
ds_read_b64_tr_b16 v[94:95], v7 offset:1536
v_and_b32 v27, s79, v49
v_add_f32 v20, v20, v26
s_add_u32 s77, s77, 1
s_mov_b32 s54, 53248
s_cmp_eq_u32 s77, 3
s_cselect_b32 s54, 4294860800, s54
s_cselect_b32 s77, 0, s77
v_mfma_f32_32x32x16_bf16 v[192:207], v[60:63], v[40:43], v[192:207]
v_add_f32 v21, v21, v27
v_lshlrev_b32 v28, 16, v50
v_and_b32 v29, s79, v50
v_add_u32 v32, s54, v32
v_add_u32 v33, s54, v33
v_add_u32 v34, s54, v34
v_add_u32 v35, s54, v35
v_mfma_f32_32x32x16_bf16 v[208:223], v[60:63], v[44:47], v[208:223]
v_add_f32 v20, v20, v28
v_add_f32 v21, v21, v29
v_lshlrev_b32 v24, 16, v51
v_add_u32 v2, s54, v2
v_add_u32 v3, s54, v3
v_add_u32 v4, s54, v4
s_add_u32 s55, s55, 1
v_mfma_f32_32x32x16_bf16 v[224:239], v[64:67], v[40:43], v[224:239]
v_and_b32 v25, s79, v51
v_add_f32 v20, v20, v24
v_add_f32 v21, v21, v25
s_waitcnt vmcnt(0)
s_cmp_eq_u32 s55, 8
v_mfma_f32_32x32x16_bf16 v[240:255], v[64:67], v[44:47], v[240:255]
v_add_u32 v5, s54, v5
v_add_u32 v6, s54, v6
v_add_u32 v7, s54, v7
s_waitcnt lgkmcnt(0)
v_mfma_f32_32x32x16_bf16 v[96:111], v[76:79], v[68:71], v[96:111]
s_cbranch_scc1 L_clast0
s_barrier
ds_read_b64_tr_b16 v[48:49], v2 offset:0
ds_read_b64_tr_b16 v[50:51], v2 offset:512
v_lshlrev_b32 v24, 16, v76
v_mfma_f32_32x32x16_bf16 v[112:127], v[76:79], v[72:75], v[112:127]
ds_read_b128 v[40:43], v32 offset:0
ds_read_b128 v[44:47], v32 offset:4096
v_and_b32 v25, s79, v76
v_mfma_f32_32x32x16_bf16 v[128:143], v[80:83], v[68:71], v[128:143]
ds_read_b64_tr_b16 v[52:53], v3 offset:0
ds_read_b64_tr_b16 v[54:55], v3 offset:512
v_add_f32 v20, v20, v24
v_mfma_f32_32x32x16_bf16 v[144:159], v[80:83], v[72:75], v[144:159]
ds_read_b64_tr_b16 v[56:57], v4 offset:0
ds_read_b64_tr_b16 v[58:59], v4 offset:512
v_add_f32 v21, v21, v25
v_mfma_f32_32x32x16_bf16 v[160:175], v[84:87], v[68:71], v[160:175]
ds_read_b64_tr_b16 v[60:61], v5 offset:0
ds_read_b64_tr_b16 v[62:63], v5 offset:512
v_lshlrev_b32 v26, 16, v77
v_mfma_f32_32x32x16_bf16 v[176:191], v[84:87], v[72:75], v[176:191]
ds_read_b64_tr_b16 v[64:65], v6 offset:0
ds_read_b64_tr_b16 v[66:67], v7 offset:0
v_and_b32 v27, s79, v77
v_add_f32 v20, v20, v26
v_mfma_f32_32x32x16_bf16 v[192:207], v[88:91], v[68:71], v[192:207]
v_add_f32 v21, v21, v27
v_lshlrev_b32 v28, 16, v78
v_and_b32 v29, s79, v78
v_mfma_f32_32x32x16_bf16 v[208:223], v[88:91], v[72:75], v[208:223]
v_add_f32 v20, v20, v28
v_add_f32 v21, v21, v29
v_lshlrev_b32 v24, 16, v79
v_mfma_f32_32x32x16_bf16 v[224:239], v[92:95], v[68:71], v[224:239]
v_and_b32 v25, s79, v79
v_add_f32 v20, v20, v24
v_add_f32 v21, v21, v25
v_mfma_f32_32x32x16_bf16 v[240:255], v[92:95], v[72:75], v[240:255]
s_branch L_cloop0
L_clast0:
v_lshlrev_b32 v24, 16, v76
v_mfma_f32_32x32x16_bf16 v[112:127], v[76:79], v[72:75], v[112:127]
v_and_b32 v25, s79, v76
v_mfma_f32_32x32x16_bf16 v[128:143], v[80:83], v[68:71], v[128:143]
v_add_f32 v20, v20, v24
v_add_f32 v21, v21, v25
v_mfma_f32_32x32x16_bf16 v[144:159], v[80:83], v[72:75], v[144:159]
v_lshlrev_b32 v26, 16, v77
v_and_b32 v27, s79, v77
v_mfma_f32_32x32x16_bf16 v[160:175], v[84:87], v[68:71], v[160:175]
v_add_f32 v20, v20, v26
v_add_f32 v21, v21, v27
v_mfma_f32_32x32x16_bf16 v[176:191], v[84:87], v[72:75], v[176:191]
v_lshlrev_b32 v28, 16, v78
v_and_b32 v29, s79, v78
v_mfma_f32_32x32x16_bf16 v[192:207], v[88:91], v[68:71], v[192:207]
v_add_f32 v20, v20, v28
v_add_f32 v21, v21, v29
v_mfma_f32_32x32x16_bf16 v[208:223], v[88:91], v[72:75], v[208:223]
v_lshlrev_b32 v24, 16, v79
v_and_b32 v25, s79, v79
v_mfma_f32_32x32x16_bf16 v[224:239], v[92:95], v[68:71], v[224:239]
v_add_f32 v20, v20, v24
v_add_f32 v21, v21, v25
v_mfma_f32_32x32x16_bf16 v[240:255], v[92:95], v[72:75], v[240:255]
s_branch L_cdone
L_cloop1:
s_waitcnt lgkmcnt(0)
v_mfma_f32_32x32x16_bf16 v[96:111], v[48:51], v[40:43], v[96:111]
ds_read_b64_tr_b16 v[76:77], v2 offset:2048
ds_read_b64_tr_b16 v[78:79], v2 offset:2560
v_lshlrev_b32 v24, 16, v52
v_mfma_f32_32x32x16_bf16 v[112:127], v[48:51], v[44:47], v[112:127]
ds_read_b128 v[68:71], v33 offset:0
ds_read_b128 v[72:75], v33 offset:4096
v_and_b32 v25, s79, v52
v_mfma_f32_32x32x16_bf16 v[128:143], v[52:55], v[40:43], v[128:143]
ds_read_b64_tr_b16 v[80:81], v3 offset:2048
ds_read_b64_tr_b16 v[82:83], v3 offset:2560
v_add_f32 v20, v20, v24
v_mfma_f32_32x32x16_bf16 v[144:159], v[52:55], v[44:47], v[144:159]
ds_read_b64_tr_b16 v[84:85], v4 offset:2048
ds_read_b64_tr_b16 v[86:87], v4 offset:2560
v_add_f32 v21, v21, v25
v_mfma_f32_32x32x16_bf16 v[160:175], v[56:59], v[40:43], v[160:175]
ds_read_b64_tr_b16 v[88:89], v5 offset:2048
ds_read_b64_tr_b16 v[90:91], v5 offset:2560
v_lshlrev_b32 v26, 16, v53
v_mfma_f32_32x32x16_bf16 v[176:191], v[56:59], v[44:47], v[176:191]
ds_read_b64_tr_b16 v[92:93], v6 offset:512
ds_read_b64_tr_b16 v[94:95], v7 offset:512
v_and_b32 v27, s79, v53
v_add_f32 v20, v20, v26
v_mfma_f32_32x32x16_bf16 v[192:207], v[60:63], v[40:43], v[192:207]
v_add_f32 v21, v21, v27
v_lshlrev_b32 v28, 16, v54
v_and_b32 v29, s79, v54
v_mfma_f32_32x32x16_bf16 v[208:223], v[60:63], v[44:47], v[208:223]
v_add_f32 v20, v20, v28
v_add_f32 v21, v21, v29
v_lshlrev_b32 v24, 16, v55
v_mfma_f32_32x32x16_bf16 v[224:239], v[64:67], v[40:43], v[224:239]
v_and_b32 v25, s79, v55
v_add_f32 v20, v20, v24
v_add_f32 v21, v21, v25
v_mfma_f32_32x32x16_bf16 v[240:255], v[64:67], v[44:47], v[240:255]
s_waitcnt lgkmcnt(0)
v_mfma_f32_32x32x16_bf16 v[96:111], v[76:79], v[68:71], v[96:111]
ds_read_b64_tr_b16 v[48:49], v2 offset:4096
ds_read_b64_tr_b16 v[50:51], v2 offset:4608
v_lshlrev_b32 v24, 16, v80
v_and_b32 v25, s79, v80
v_add_f32 v20, v20, v24
v_mfma_f32_32x32x16_bf16 v[112:127], v[76:79], v[72:75], v[112:127]
ds_read_b128 v[40:43], v34 offset:0
ds_read_b128 v[44:47], v34 offset:4096
v_add_f32 v21, v21, v25
v_lshlrev_b32 v26, 16, v81
v_and_b32 v27, s79, v81
v_mfma_f32_32x32x16_bf16 v[128:143], v[80:83], v[68:71], v[128:143]
ds_read_b64_tr_b16 v[52:53], v3 offset:4096
ds_read_b64_tr_b16 v[54:55], v3 offset:4608
v_add_f32 v20, v20, v26
v_add_f32 v21, v21, v27
v_lshlrev_b32 v28, 16, v82
v_mfma_f32_32x32x16_bf16 v[144:159], v[80:83], v[72:75], v[144:159]
ds_read_b64_tr_b16 v[56:57], v4 offset:4096
ds_read_b64_tr_b16 v[58:59], v4 offset:4608
v_and_b32 v29, s79, v82
v_add_f32 v20, v20, v28
v_add_f32 v21, v21, v29
v_mfma_f32_32x32x16_bf16 v[160:175], v[84:87], v[68:71], v[160:175]
ds_read_b64_tr_b16 v[60:61], v5 offset:4096
ds_read_b64_tr_b16 v[62:63], v5 offset:4608
v_lshlrev_b32 v24, 16, v83
v_and_b32 v25, s79, v83
v_add_f32 v20, v20, v24
v_mfma_f32_32x32x16_bf16 v[176:191], v[84:87], v[72:75], v[176:191]
ds_read_b64_tr_b16 v[64:65], v6 offset:1024
ds_read_b64_tr_b16 v[66:67], v7 offset:1024
v_add_f32 v21, v21, v25
v_lshlrev_b32 v26, 16, v92
v_and_b32 v27, s79, v92
v_mfma_f32_32x32x16_bf16 v[192:207], v[88:91], v[68:71], v[192:207]
v_add_f32 v22, v22, v26
v_add_f32 v23, v23, v27
v_lshlrev_b32 v28, 16, v93
v_and_b32 v29, s79, v93
v_mfma_f32_32x32x16_bf16 v[208:223], v[88:91], v[72:75], v[208:223]
v_add_f32 v22, v22, v28
v_add_f32 v23, v23, v29
v_lshlrev_b32 v24, 16, v94
v_and_b32 v25, s79, v94
v_add_f32 v22, v22, v24
v_mfma_f32_32x32x16_bf16 v[224:239], v[92:95], v[68:71], v[224:239]
v_add_f32 v23, v23, v25
v_lshlrev_b32 v26, 16, v95
v_and_b32 v27, s79, v95
v_add_f32 v22, v22, v26
v_add_f32 v23, v23, v27
v_mfma_f32_32x32x16_bf16 v[240:255], v[92:95], v[72:75], v[240:255]
s_waitcnt lgkmcnt(0)
v_mfma_f32_32x32x16_bf16 v[96:111], v[48:51], v[40:43], v[96:111]
ds_read_b64_tr_b16 v[76:77], v2 offset:6144
ds_read_b64_tr_b16 v[78:79], v2 offset:6656
v_lshlrev_b32 v24, 16, v52
v_mfma_f32_32x32x16_bf16 v[112:127], v[48:51], v[44:47], v[112:127]
ds_read_b128 v[68:71], v35 offset:0
ds_read_b128 v[72:75], v35 offset:4096
v_and_b32 v25, s79, v52
v_mfma_f32_32x32x16_bf16 v[128:143], v[52:55], v[40:43], v[128:143]
ds_read_b64_tr_b16 v[80:81], v3 offset:6144
ds_read_b64_tr_b16 v[82:83], v3 offset:6656
v_add_f32 v20, v20, v24
v_mfma_f32_32x32x16_bf16 v[144:159], v[52:55], v[44:47], v[144:159]
ds_read_b64_tr_b16 v[84:85], v4 offset:6144
ds_read_b64_tr_b16 v[86:87], v4 offset:6656
v_add_f32 v21, v21, v25
v_mfma_f32_32x32x16_bf16 v[160:175], v[56:59], v[40:43], v[160:175]
ds_read_b64_tr_b16 v[88:89], v5 offset:6144
ds_read_b64_tr_b16 v[90:91], v5 offset:6656
v_lshlrev_b32 v26, 16, v53
v_mfma_f32_32x32x16_bf16 v[176:191], v[56:59], v[44:47], v[176:191]
ds_read_b64_tr_b16 v[92:93], v6 offset:1536
ds_read_b64_tr_b16 v[94:95], v7 offset:1536
v_and_b32 v27, s79, v53
v_add_f32 v20, v20, v26
s_add_u32 s77, s77, 1
s_mov_b32 s54, 53248
s_cmp_eq_u32 s77, 3
s_cselect_b32 s54, 4294860800, s54
s_cselect_b32 s77, 0, s77
v_mfma_f32_32x32x16_bf16 v[192:207], v[60:63], v[40:43], v[192:207]
v_add_f32 v21, v21, v27
v_lshlrev_b32 v28, 16, v54
v_and_b32 v29, s79, v54
v_add_u32 v32, s54, v32
v_add_u32 v33, s54, v33
v_add_u32 v34, s54, v34
v_add_u32 v35, s54, v35
v_mfma_f32_32x32x16_bf16 v[208:223], v[60:63], v[44:47], v[208:223]
v_add_f32 v20, v20, v28
v_add_f32 v21, v21, v29
v_lshlrev_b32 v24, 16, v55
v_add_u32 v2, s54, v2
v_add_u32 v3, s54, v3
v_add_u32 v4, s54, v4
s_add_u32 s55, s55, 1
v_mfma_f32_32x32x16_bf16 v[224:239], v[64:67], v[40:43], v[224:239]
v_and_b32 v25, s79, v55
v_add_f32 v20, v20, v24
v_add_f32 v21, v21, v25
s_waitcnt vmcnt(0)
s_cmp_eq_u32 s55, 8
v_mfma_f32_32x32x16_bf16 v[240:255], v[64:67], v[44:47], v[240:255]
v_add_u32 v5, s54, v5
v_add_u32 v6, s54, v6
v_add_u32 v7, s54, v7
s_waitcnt lgkmcnt(0)
v_mfma_f32_32x32x16_bf16 v[96:111], v[76:79], v[68:71], v[96:111]
s_cbranch_scc1 L_clast1
s_barrier
ds_read_b64_tr_b16 v[48:49], v2 offset:0
ds_read_b64_tr_b16 v[50:51], v2 offset:512
v_lshlrev_b32 v24, 16, v80
v_mfma_f32_32x32x16_bf16 v[112:127], v[76:79], v[72:75], v[112:127]
ds_read_b128 v[40:43], v32 offset:0
ds_read_b128 v[44:47], v32 offset:4096
v_and_b32 v25, s79, v80
v_mfma_f32_32x32x16_bf16 v[128:143], v[80:83], v[68:71], v[128:143]
ds_read_b64_tr_b16 v[52:53], v3 offset:0
ds_read_b64_tr_b16 v[54:55], v3 offset:512
v_add_f32 v20, v20, v24
v_mfma_f32_32x32x16_bf16 v[144:159], v[80:83], v[72:75], v[144:159]
ds_read_b64_tr_b16 v[56:57], v4 offset:0
ds_read_b64_tr_b16 v[58:59], v4 offset:512
v_add_f32 v21, v21, v25
v_mfma_f32_32x32x16_bf16 v[160:175], v[84:87], v[68:71], v[160:175]
ds_read_b64_tr_b16 v[60:61], v5 offset:0
ds_read_b64_tr_b16 v[62:63], v5 offset:512
v_lshlrev_b32 v26, 16, v81
v_mfma_f32_32x32x16_bf16 v[176:191], v[84:87], v[72:75], v[176:191]
ds_read_b64_tr_b16 v[64:65], v6 offset:0
ds_read_b64_tr_b16 v[66:67], v7 offset:0
v_and_b32 v27, s79, v81
v_add_f32 v20, v20, v26
v_mfma_f32_32x32x16_bf16 v[192:207], v[88:91], v[68:71], v[192:207]
v_add_f32 v21, v21, v27
v_lshlrev_b32 v28, 16, v82
v_and_b32 v29, s79, v82
v_mfma_f32_32x32x16_bf16 v[208:223], v[88:91], v[72:75], v[208:223]
v_add_f32 v20, v20, v28
v_add_f32 v21, v21, v29
v_lshlrev_b32 v24, 16, v83
v_mfma_f32_32x32x16_bf16 v[224:239], v[92:95], v[68:71], v[224:239]
v_and_b32 v25, s79, v83
v_add_f32 v20, v20, v24
v_add_f32 v21, v21, v25
v_mfma_f32_32x32x16_bf16 v[240:255], v[92:95], v[72:75], v[240:255]
s_branch L_cloop1
L_clast1:
v_lshlrev_b32 v24, 16, v80
v_mfma_f32_32x32x16_bf16 v[112:127], v[76:79], v[72:75], v[112:127]
v_and_b32 v25, s79, v80
v_mfma_f32_32x32x16_bf16 v[128:143], v[80:83], v[68:71], v[128:143]
v_add_f32 v20, v20, v24
v_add_f32 v21, v21, v25
v_mfma_f32_32x32x16_bf16 v[144:159], v[80:83], v[72:75], v[144:159]
v_lshlrev_b32 v26, 16, v81
v_and_b32 v27, s79, v81
v_mfma_f32_32x32x16_bf16 v[160:175], v[84:87], v[68:71], v[160:175]
v_add_f32 v20, v20, v26
v_add_f32 v21, v21, v27
v_mfma_f32_32x32x16_bf16 v[176:191], v[84:87], v[72:75], v[176:191]
v_lshlrev_b32 v28, 16, v82
v_and_b32 v29, s79, v82
v_mfma_f32_32x32x16_bf16 v[192:207], v[88:91], v[68:71], v[192:207]
v_add_f32 v20, v20, v28
v_add_f32 v21, v21, v29
v_mfma_f32_32x32x16_bf16 v[208:223], v[88:91], v[72:75], v[208:223]
v_lshlrev_b32 v24, 16, v83
v_and_b32 v25, s79, v83
v_mfma_f32_32x32x16_bf16 v[224:239], v[92:95], v[68:71], v[224:239]
v_add_f32 v20, v20, v24
v_add_f32 v21, v21, v25
v_mfma_f32_32x32x16_bf16 v[240:255], v[92:95], v[72:75], v[240:255]
s_branch L_cdone
L_cloop2:
s_waitcnt lgkmcnt(0)
v_mfma_f32_32x32x16_bf16 v[96:111], v[48:51], v[40:43], v[96:111]
ds_read_b64_tr_b16 v[76:77], v2 offset:2048
ds_read_b64_tr_b16 v[78:79], v2 offset:2560
v_lshlrev_b32 v24, 16, v56
v_mfma_f32_32x32x16_bf16 v[112:127], v[48:51], v[44:47], v[112:127]
ds_read_b128 v[68:71], v33 offset:0
ds_read_b128 v[72:75], v33 offset:4096
v_and_b32 v25, s79, v56
v_mfma_f32_32x32x16_bf16 v[128:143], v[52:55], v[40:43], v[128:143]
ds_read_b64_tr_b16 v[80:81], v3 offset:2048
ds_read_b64_tr_b16 v[82:83], v3 offset:2560
v_add_f32 v20, v20, v24
v_mfma_f32_32x32x16_bf16 v[144:159], v[52:55], v[44:47], v[144:159]
ds_read_b64_tr_b16 v[84:85], v4 offset:2048
ds_read_b64_tr_b16 v[86:87], v4 offset:2560
v_add_f32 v21, v21, v25
v_mfma_f32_32x32x16_bf16 v[160:175], v[56:59], v[40:43], v[160:175]
ds_read_b64_tr_b16 v[88:89], v5 offset:2048
ds_read_b64_tr_b16 v[90:91], v5 offset:2560
v_lshlrev_b32 v26, 16, v57
v_mfma_f32_32x32x16_bf16 v[176:191], v[56:59], v[44:47], v[176:191]
ds_read_b64_tr_b16 v[92:93], v6 offset:512
ds_read_b64_tr_b16 v[94:95], v7 offset:512
v_and_b32 v27, s79, v57
v_add_f32 v20, v20, v26
v_mfma_f32_32x32x16_bf16 v[192:207], v[60:63], v[40:43], v[192:207]
v_add_f32 v21, v21, v27
v_lshlrev_b32 v28, 16, v58
v_and_b32 v29, s79, v58
v_mfma_f32_32x32x16_bf16 v[208:223], v[60:63], v[44:47], v[208:223]
v_add_f32 v20, v20, v28
v_add_f32 v21, v21, v29
v_lshlrev_b32 v24, 16, v59
v_mfma_f32_32x32x16_bf16 v[224:239], v[64:67], v[40:43], v[224:239]
v_and_b32 v25, s79, v59
v_add_f32 v20, v20, v24
v_add_f32 v21, v21, v25
v_mfma_f32_32x32x16_bf16 v[240:255], v[64:67], v[44:47], v[240:255]
s_waitcnt lgkmcnt(0)
v_mfma_f32_32x32x16_bf16 v[96:111], v[76:79], v[68:71], v[96:111]
ds_read_b64_tr_b16 v[48:49], v2 offset:4096
ds_read_b64_tr_b16 v[50:51], v2 offset:4608
v_lshlrev_b32 v24, 16, v84
v_mfma_f32_32x32x16_bf16 v[112:127], v[76:79], v[72:75], v[112:127]
ds_read_b128 v[40:43], v34 offset:0
ds_read_b128 v[44:47], v34 offset:4096
v_and_b32 v25, s79, v84
v_mfma_f32_32x32x16_bf16 v[128:143], v[80:83], v[68:71], v[128:143]
ds_read_b64_tr_b16 v[52:53], v3 offset:4096
ds_read_b64_tr_b16 v[54:55], v3 offset:4608
v_add_f32 v20, v20, v24
v_mfma_f32_32x32x16_bf16 v[144:159], v[80:83], v[72:75], v[144:159]
ds_read_b64_tr_b16 v[56:57], v4 offset:4096
ds_read_b64_tr_b16 v[58:59], v4 offset:4608
v_add_f32 v21, v21, v25
v_mfma_f32_32x32x16_bf16 v[160:175], v[84:87], v[68:71], v[160:175]
ds_read_b64_tr_b16 v[60:61], v5 offset:4096
ds_read_b64_tr_b16 v[62:63], v5 offset:4608
v_lshlrev_b32 v26, 16, v85
v_mfma_f32_32x32x16_bf16 v[176:191], v[84:87], v[72:75], v[176:191]
ds_read_b64_tr_b16 v[64:65], v6 offset:1024
ds_read_b64_tr_b16 v[66:67], v7 offset:1024
v_and_b32 v27, s79, v85
v_add_f32 v20, v20, v26
v_mfma_f32_32x32x16_bf16 v[192:207], v[88:91], v[68:71], v[192:207]
v_add_f32 v21, v21, v27
v_lshlrev_b32 v28, 16, v86
v_and_b32 v29, s79, v86
v_mfma_f32_32x32x16_bf16 v[208:223], v[88:91], v[72:75], v[208:223]
v_add_f32 v20, v20, v28
v_add_f32 v21, v21, v29
v_lshlrev_b32 v24, 16, v87
v_mfma_f32_32x32x16_bf16 v[224:239], v[92:95], v[68:71], v[224:239]
v_and_b32 v25, s79, v87
v_add_f32 v20, v20, v24
v_add_f32 v21, v21, v25
v_mfma_f32_32x32x16_bf16 v[240:255], v[92:95], v[72:75], v[240:255]
s_waitcnt lgkmcnt(0)
v_mfma_f32_32x32x16_bf16 v[96:111], v[48:51], v[40:43], v[96:111]
ds_read_b64_tr_b16 v[76:77], v2 offset:6144
ds_read_b64_tr_b16 v[78:79], v2 offset:6656
v_lshlrev_b32 v24, 16, v56
v_and_b32 v25, s79, v56
v_add_f32 v20, v20, v24
v_mfma_f32_32x32x16_bf16 v[112:127], v[48:51], v[44:47], v[112:127]
ds_read_b128 v[68:71], v35 offset:0
ds_read_b128 v[72:75], v35 offset:4096
v_add_f32 v21, v21, v25
v_lshlrev_b32 v26, 16, v57
v_and_b32 v27, s79, v57
v_mfma_f32_32x32x16_bf16 v[128:143], v[52:55], v[40:43], v[128:143]
ds_read_b64_tr_b16 v[80:81], v3 offset:6144
ds_read_b64_tr_b16 v[82:83], v3 offset:6656
v_add_f32 v20, v20, v26
v_add_f32 v21, v21, v27
v_lshlrev_b32 v28, 16, v58
v_mfma_f32_32x32x16_bf16 v[144:159], v[52:55], v[44:47], v[144:159]
ds_read_b64_tr_b16 v[84:85], v4 offset:6144
ds_read_b64_tr_b16 v[86:87], v4 offset:6656
v_and_b32 v29, s79, v58
v_add_f32 v20, v20, v28
v_add_f32 v21, v21, v29
v_mfma_f32_32x32x16_bf16 v[160:175], v[56:59], v[40:43], v[160:175]
ds_read_b64_tr_b16 v[88:89], v5 offset:6144
ds_read_b64_tr_b16 v[90:91], v5 offset:6656
v_lshlrev_b32 v24, 16, v59
v_and_b32 v25, s79, v59
v_add_f32 v20, v20, v24
v_mfma_f32_32x32x16_bf16 v[176:191], v[56:59], v[44:47], v[176:191]
ds_read_b64_tr_b16 v[92:93], v6 offset:1536
ds_read_b64_tr_b16 v[94:95], v7 offset:1536
v_add_f32 v21, v21, v25
v_lshlrev_b32 v26, 16, v64
v_and_b32 v27, s79, v64
s_add_u32 s77, s77, 1
s_mov_b32 s54, 53248
s_cmp_eq_u32 s77, 3
s_cselect_b32 s54, 4294860800, s54
s_cselect_b32 s77, 0, s77
v_mfma_f32_32x32x16_bf16 v[192:207], v[60:63], v[40:43], v[192:207]
v_add_f32 v22, v22, v26
v_add_f32 v23, v23, v27
v_lshlrev_b32 v28, 16, v65
v_and_b32 v29, s79, v65
v_add_u32 v32, s54, v32
v_add_u32 v33, s54, v33
v_add_u32 v34, s54, v34
v_add_u32 v35, s54, v35
v_mfma_f32_32x32x16_bf16 v[208:223], v[60:63], v[44:47], v[208:223]
v_add_f32 v22, v22, v28
v_add_f32 v23, v23, v29
v_lshlrev_b32 v24, 16, v66
v_and_b32 v25, s79, v66
v_add_f32 v22, v22, v24
v_add_u32 v2, s54, v2
v_add_u32 v3, s54, v3
v_add_u32 v4, s54, v4
s_add_u32 s55, s55, 1
v_mfma_f32_32x32x16_bf16 v[224:239], v[64:67], v[40:43], v[224:239]
v_add_f32 v23, v23, v25
v_lshlrev_b32 v26, 16, v67
v_and_b32 v27, s79, v67
v_add_f32 v22, v22, v26
v_add_f32 v23, v23, v27
s_waitcnt vmcnt(0)
s_cmp_eq_u32 s55, 8
v_mfma_f32_32x32x16_bf16 v[240:255], v[64:67], v[44:47], v[240:255]
v_add_u32 v5, s54, v5
v_add_u32 v6, s54, v6
v_add_u32 v7, s54, v7
s_waitcnt lgkmcnt(0)
v_mfma_f32_32x32x16_bf16 v[96:111], v[76:79], v[68:71], v[96:111]
s_cbranch_scc1 L_clast2
s_barrier
ds_read_b64_tr_b16 v[48:49], v2 offset:0
ds_read_b64_tr_b16 v[50:51], v2 offset:512
v_lshlrev_b32 v24, 16, v84
v_mfma_f32_32x32x16_bf16 v[112:127], v[76:79], v[72:75], v[112:127]
ds_read_b128 v[40:43], v32 offset:0
ds_read_b128 v[44:47], v32 offset:4096
v_and_b32 v25, s79, v84
v_mfma_f32_32x32x16_bf16 v[128:143], v[80:83], v[68:71], v[128:143]
ds_read_b64_tr_b16 v[52:53], v3 offset:0
ds_read_b64_tr_b16 v[54:55], v3 offset:512
v_add_f32 v20, v20, v24
v_mfma_f32_32x32x16_bf16 v[144:159], v[80:83], v[72:75], v[144:159]
ds_read_b64_tr_b16 v[56:57], v4 offset:0
ds_read_b64_tr_b16 v[58:59], v4 offset:512
v_add_f32 v21, v21, v25
v_mfma_f32_32x32x16_bf16 v[160:175], v[84:87], v[68:71], v[160:175]
ds_read_b64_tr_b16 v[60:61], v5 offset:0
ds_read_b64_tr_b16 v[62:63], v5 offset:512
v_lshlrev_b32 v26, 16, v85
v_mfma_f32_32x32x16_bf16 v[176:191], v[84:87], v[72:75], v[176:191]
ds_read_b64_tr_b16 v[64:65], v6 offset:0
ds_read_b64_tr_b16 v[66:67], v7 offset:0
v_and_b32 v27, s79, v85
v_add_f32 v20, v20, v26
v_mfma_f32_32x32x16_bf16 v[192:207], v[88:91], v[68:71], v[192:207]
v_add_f32 v21, v21, v27
v_lshlrev_b32 v28, 16, v86
v_and_b32 v29, s79, v86
v_mfma_f32_32x32x16_bf16 v[208:223], v[88:91], v[72:75], v[208:223]
v_add_f32 v20, v20, v28
v_add_f32 v21, v21, v29
v_lshlrev_b32 v24, 16, v87
v_mfma_f32_32x32x16_bf16 v[224:239], v[92:95], v[68:71], v[224:239]
v_and_b32 v25, s79, v87
v_add_f32 v20, v20, v24
v_add_f32 v21, v21, v25
v_mfma_f32_32x32x16_bf16 v[240:255], v[92:95], v[72:75], v[240:255]
s_branch L_cloop2
L_clast2:
v_lshlrev_b32 v24, 16, v84
v_mfma_f32_32x32x16_bf16 v[112:127], v[76:79], v[72:75], v[112:127]
v_and_b32 v25, s79, v84
v_mfma_f32_32x32x16_bf16 v[128:143], v[80:83], v[68:71], v[128:143]
v_add_f32 v20, v20, v24
v_add_f32 v21, v21, v25
v_mfma_f32_32x32x16_bf16 v[144:159], v[80:83], v[72:75], v[144:159]
v_lshlrev_b32 v26, 16, v85
v_and_b32 v27, s79, v85
v_mfma_f32_32x32x16_bf16 v[160:175], v[84:87], v[68:71], v[160:175]
v_add_f32 v20, v20, v26
v_add_f32 v21, v21, v27
v_mfma_f32_32x32x16_bf16 v[176:191], v[84:87], v[72:75], v[176:191]
v_lshlrev_b32 v28, 16, v86
v_and_b32 v29, s79, v86
v_mfma_f32_32x32x16_bf16 v[192:207], v[88:91], v[68:71], v[192:207]
v_add_f32 v20, v20, v28
v_add_f32 v21, v21, v29
v_mfma_f32_32x32x16_bf16 v[208:223], v[88:91], v[72:75], v[208:223]
v_lshlrev_b32 v24, 16, v87
v_and_b32 v25, s79, v87
v_mfma_f32_32x32x16_bf16 v[224:239], v[92:95], v[68:71], v[224:239]
v_add_f32 v20, v20, v24
v_add_f32 v21, v21, v25
v_mfma_f32_32x32x16_bf16 v[240:255], v[92:95], v[72:75], v[240:255]
s_branch L_cdone
L_cloop3:
s_waitcnt lgkmcnt(0)
v_mfma_f32_32x32x16_bf16 v[96:111], v[48:51], v[40:43], v[96:111]
ds_read_b64_tr_b16 v[76:77], v2 offset:2048
ds_read_b64_tr_b16 v[78:79], v2 offset:2560
v_lshlrev_b32 v24, 16, v60
v_mfma_f32_32x32x16_bf16 v[112:127], v[48:51], v[44:47], v[112:127]
ds_read_b128 v[68:71], v33 offset:0
ds_read_b128 v[72:75], v33 offset:4096
v_and_b32 v25, s79, v60
v_mfma_f32_32x32x16_bf16 v[128:143], v[52:55], v[40:43], v[128:143]
ds_read_b64_tr_b16 v[80:81], v3 offset:2048
ds_read_b64_tr_b16 v[82:83], v3 offset:2560
v_add_f32 v20, v20, v24
v_mfma_f32_32x32x16_bf16 v[144:159], v[52:55], v[44:47], v[144:159]
ds_read_b64_tr_b16 v[84:85], v4 offset:2048
ds_read_b64_tr_b16 v[86:87], v4 offset:2560
v_add_f32 v21, v21, v25
v_mfma_f32_32x32x16_bf16 v[160:175], v[56:59], v[40:43], v[160:175]
ds_read_b64_tr_b16 v[88:89], v5 offset:2048
ds_read_b64_tr_b16 v[90:91], v5 offset:2560
v_lshlrev_b32 v26, 16, v61
v_mfma_f32_32x32x16_bf16 v[176:191], v[56:59], v[44:47], v[176:191]
ds_read_b64_tr_b16 v[92:93], v6 offset:512
ds_read_b64_tr_b16 v[94:95], v7 offset:512
v_and_b32 v27, s79, v61
v_add_f32 v20, v20, v26
v_mfma_f32_32x32x16_bf16 v[192:207], v[60:63], v[40:43], v[192:207]
v_add_f32 v21, v21, v27
v_lshlrev_b32 v28, 16, v62
v_and_b32 v29, s79, v62
v_mfma_f32_32x32x16_bf16 v[208:223], v[60:63], v[44:47], v[208:223]
v_add_f32 v20, v20, v28
v_add_f32 v21, v21, v29
v_lshlrev_b32 v24, 16, v63
v_mfma_f32_32x32x16_bf16 v[224:239], v[64:67], v[40:43], v[224:239]
v_and_b32 v25, s79, v63
v_add_f32 v20, v20, v24
v_add_f32 v21, v21, v25
v_mfma_f32_32x32x16_bf16 v[240:255], v[64:67], v[44:47], v[240:255]
s_waitcnt lgkmcnt(0)
v_mfma_f32_32x32x16_bf16 v[96:111], v[76:79], v[68:71], v[96:111]
ds_read_b64_tr_b16 v[48:49], v2 offset:4096
ds_read_b64_tr_b16 v[50:51], v2 offset:4608
v_lshlrev_b32 v24, 16, v88
v_mfma_f32_32x32x16_bf16 v[112:127], v[76:79], v[72:75], v[112:127]
ds_read_b128 v[40:43], v34 offset:0
ds_read_b128 v[44:47], v34 offset:4096
v_and_b32 v25, s79, v88
v_mfma_f32_32x32x16_bf16 v[128:143], v[80:83], v[68:71], v[128:143]
ds_read_b64_tr_b16 v[52:53], v3 offset:4096
ds_read_b64_tr_b16 v[54:55], v3 offset:4608
v_add_f32 v20, v20, v24
v_mfma_f32_32x32x16_bf16 v[144:159], v[80:83], v[72:75], v[144:159]
ds_read_b64_tr_b16 v[56:57], v4 offset:4096
ds_read_b64_tr_b16 v[58:59], v4 offset:4608
v_add_f32 v21, v21, v25
v_mfma_f32_32x32x16_bf16 v[160:175], v[84:87], v[68:71], v[160:175]
ds_read_b64_tr_b16 v[60:61], v5 offset:4096
ds_read_b64_tr_b16 v[62:63], v5 offset:4608
v_lshlrev_b32 v26, 16, v89
v_mfma_f32_32x32x16_bf16 v[176:191], v[84:87], v[72:75], v[176:191]
ds_read_b64_tr_b16 v[64:65], v6 offset:1024
ds_read_b64_tr_b16 v[66:67], v7 offset:1024
v_and_b32 v27, s79, v89
v_add_f32 v20, v20, v26
v_mfma_f32_32x32x16_bf16 v[192:207], v[88:91], v[68:71], v[192:207]
v_add_f32 v21, v21, v27
v_lshlrev_b32 v28, 16, v90
v_and_b32 v29, s79, v90
v_mfma_f32_32x32x16_bf16 v[208:223], v[88:91], v[72:75], v[208:223]
v_add_f32 v20, v20, v28
v_add_f32 v21, v21, v29
v_lshlrev_b32 v24, 16, v91
v_mfma_f32_32x32x16_bf16 v[224:239], v[92:95], v[68:71], v[224:239]
v_and_b32 v25, s79, v91
v_add_f32 v20, v20, v24
v_add_f32 v21, v21, v25
v_mfma_f32_32x32x16_bf16 v[240:255], v[92:95], v[72:75], v[240:255]
s_waitcnt lgkmcnt(0)
v_mfma_f32_32x32x16_bf16 v[96:111], v[48:51], v[40:43], v[96:111]
ds_read_b64_tr_b16 v[76:77], v2 offset:6144
ds_read_b64_tr_b16 v[78:79], v2 offset:6656
v_lshlrev_b32 v24, 16, v60
v_mfma_f32_32x32x16_bf16 v[112:127], v[48:51], v[44:47], v[112:127]
ds_read_b128 v[68:71], v35 offset:0
ds_read_b128 v[72:75], v35 offset:4096
v_and_b32 v25, s79, v60
v_mfma_f32_32x32x16_bf16 v[128:143], v[52:55], v[40:43], v[128:143]
ds_read_b64_tr_b16 v[80:81], v3 offset:6144
ds_read_b64_tr_b16 v[82:83], v3 offset:6656
v_add_f32 v20, v20, v24
v_mfma_f32_32x32x16_bf16 v[144:159], v[52:55], v[44:47], v[144:159]
ds_read_b64_tr_b16 v[84:85], v4 offset:6144
ds_read_b64_tr_b16 v[86:87], v4 offset:6656
v_add_f32 v21, v21, v25
v_mfma_f32_32x32x16_bf16 v[160:175], v[56:59], v[40:43], v[160:175]
ds_read_b64_tr_b16 v[88:89], v5 offset:6144
ds_read_b64_tr_b16 v[90:91], v5 offset:6656
v_lshlrev_b32 v26, 16, v61
v_mfma_f32_32x32x16_bf16 v[176:191], v[56:59], v[44:47], v[176:191]
ds_read_b64_tr_b16 v[92:93], v6 offset:1536
ds_read_b64_tr_b16 v[94:95], v7 offset:1536
v_and_b32 v27, s79, v61
v_add_f32 v20, v20, v26
s_add_u32 s77, s77, 1
s_mov_b32 s54, 53248
s_cmp_eq_u32 s77, 3
s_cselect_b32 s54, 4294860800, s54
s_cselect_b32 s77, 0, s77
v_mfma_f32_32x32x16_bf16 v[192:207], v[60:63], v[40:43], v[192:207]
v_add_f32 v21, v21, v27
v_lshlrev_b32 v28, 16, v62
v_and_b32 v29, s79, v62
v_add_u32 v32, s54, v32
v_add_u32 v33, s54, v33
v_add_u32 v34, s54, v34
v_add_u32 v35, s54, v35
v_mfma_f32_32x32x16_bf16 v[208:223], v[60:63], v[44:47], v[208:223]
v_add_f32 v20, v20, v28
v_add_f32 v21, v21, v29
v_lshlrev_b32 v24, 16, v63
v_add_u32 v2, s54, v2
v_add_u32 v3, s54, v3
v_add_u32 v4, s54, v4
s_add_u32 s55, s55, 1
v_mfma_f32_32x32x16_bf16 v[224:239], v[64:67], v[40:43], v[224:239]
v_and_b32 v25, s79, v63
v_add_f32 v20, v20, v24
v_add_f32 v21, v21, v25
s_waitcnt vmcnt(0)
s_cmp_eq_u32 s55, 8
v_mfma_f32_32x32x16_bf16 v[240:255], v[64:67], v[44:47], v[240:255]
v_add_u32 v5, s54, v5
v_add_u32 v6, s54, v6
v_add_u32 v7, s54, v7
s_waitcnt lgkmcnt(0)
v_mfma_f32_32x32x16_bf16 v[96:111], v[76:79], v[68:71], v[96:111]
s_cbranch_scc1 L_clast3
s_barrier
ds_read_b64_tr_b16 v[48:49], v2 offset:0
ds_read_b64_tr_b16 v[50:51], v2 offset:512
v_lshlrev_b32 v24, 16, v88
v_and_b32 v25, s79, v88
v_add_f32 v20, v20, v24
v_mfma_f32_32x32x16_bf16 v[112:127], v[76:79], v[72:75], v[112:127]
ds_read_b128 v[40:43], v32 offset:0
ds_read_b128 v[44:47], v32 offset:4096
v_add_f32 v21, v21, v25
v_lshlrev_b32 v26, 16, v89
v_and_b32 v27, s79, v89
v_mfma_f32_32x32x16_bf16 v[128:143], v[80:83], v[68:71], v[128:143]
ds_read_b64_tr_b16 v[52:53], v3 offset:0
ds_read_b64_tr_b16 v[54:55], v3 offset:512
v_add_f32 v20, v20, v26
v_add_f32 v21, v21, v27
v_lshlrev_b32 v28, 16, v90
v_mfma_f32_32x32x16_bf16 v[144:159], v[80:83], v[72:75], v[144:159]
ds_read_b64_tr_b16 v[56:57], v4 offset:0
ds_read_b64_tr_b16 v[58:59], v4 offset:512
v_and_b32 v29, s79, v90
v_add_f32 v20, v20, v28
v_add_f32 v21, v21, v29
v_mfma_f32_32x32x16_bf16 v[160:175], v[84:87], v[68:71], v[160:175]
ds_read_b64_tr_b16 v[60:61], v5 offset:0
ds_read_b64_tr_b16 v[62:63], v5 offset:512
v_lshlrev_b32 v24, 16, v91
v_and_b32 v25, s79, v91
v_add_f32 v20, v20, v24
v_mfma_f32_32x32x16_bf16 v[176:191], v[84:87], v[72:75], v[176:191]
ds_read_b64_tr_b16 v[64:65], v6 offset:0
ds_read_b64_tr_b16 v[66:67], v7 offset:0
v_add_f32 v21, v21, v25
v_lshlrev_b32 v26, 16, v92
v_and_b32 v27, s79, v92
v_mfma_f32_32x32x16_bf16 v[192:207], v[88:91], v[68:71], v[192:207]
v_add_f32 v22, v22, v26
v_add_f32 v23, v23, v27
v_lshlrev_b32 v28, 16, v93
v_and_b32 v29, s79, v93
v_mfma_f32_32x32x16_bf16 v[208:223], v[88:91], v[72:75], v[208:223]
v_add_f32 v22, v22, v28
v_add_f32 v23, v23, v29
v_lshlrev_b32 v24, 16, v94
v_and_b32 v25, s79, v94
v_add_f32 v22, v22, v24
v_mfma_f32_32x32x16_bf16 v[224:239], v[92:95], v[68:71], v[224:239]
v_add_f32 v23, v23, v25
v_lshlrev_b32 v26, 16, v95
v_and_b32 v27, s79, v95
v_add_f32 v22, v22, v26
v_add_f32 v23, v23, v27
v_mfma_f32_32x32x16_bf16 v[240:255], v[92:95], v[72:75], v[240:255]
s_branch L_cloop3
L_clast3:
v_lshlrev_b32 v24, 16, v88
v_and_b32 v25, s79, v88
v_add_f32 v20, v20, v24
v_mfma_f32_32x32x16_bf16 v[112:127], v[76:79], v[72:75], v[112:127]
v_add_f32 v21, v21, v25
v_lshlrev_b32 v26, 16, v89
v_and_b32 v27, s79, v89
v_mfma_f32_32x32x16_bf16 v[128:143], v[80:83], v[68:71], v[128:143]
v_add_f32 v20, v20, v26
v_add_f32 v21, v21, v27
v_lshlrev_b32 v28, 16, v90
v_mfma_f32_32x32x16_bf16 v[144:159], v[80:83], v[72:75], v[144:159]
v_and_b32 v29, s79, v90
v_add_f32 v20, v20, v28
v_add_f32 v21, v21, v29
v_mfma_f32_32x32x16_bf16 v[160:175], v[84:87], v[68:71], v[160:175]
v_lshlrev_b32 v24, 16, v91
v_and_b32 v25, s79, v91
v_add_f32 v20, v20, v24
v_add_f32 v21, v21, v25
v_mfma_f32_32x32x16_bf16 v[176:191], v[84:87], v[72:75], v[176:191]
v_lshlrev_b32 v26, 16, v92
v_and_b32 v27, s79, v92
v_add_f32 v22, v22, v26
v_add_f32 v23, v23, v27
v_mfma_f32_32x32x16_bf16 v[192:207], v[88:91], v[68:71], v[192:207]
v_lshlrev_b32 v28, 16, v93
v_and_b32 v29, s79, v93
v_add_f32 v22, v22, v28
v_add_f32 v23, v23, v29
v_mfma_f32_32x32x16_bf16 v[208:223], v[88:91], v[72:75], v[208:223]
v_lshlrev_b32 v24, 16, v94
v_and_b32 v25, s79, v94
v_add_f32 v22, v22, v24
v_add_f32 v23, v23, v25
v_mfma_f32_32x32x16_bf16 v[224:239], v[92:95], v[68:71], v[224:239]
v_lshlrev_b32 v26, 16, v95
v_and_b32 v27, s79, v95
v_add_f32 v22, v22, v26
v_add_f32 v23, v23, v27
v_mfma_f32_32x32x16_bf16 v[240:255], v[92:95], v[72:75], v[240:255]
L_cdone:
v_add_f32 v20, v20, v21
v_add_f32 v22, v22, v23
v_mov_b32 v24, v20
v_mov_b32 v25, v22
v_bfe_u32 v26, v0, 2, 1
v_lshlrev_b32 v26, 3, v26
v_permlane32_swap_b32 v20, v24
v_permlane32_swap_b32 v22, v25
v_bfe_u32 v27, v0, 3, 1
v_lshl_add_u32 v26, v27, 2, v26
v_and_b32 v27, 3, v0
v_add_u32 v26, v26, v27
v_bfe_u32 v27, v0, 4, 1
v_lshl_add_u32 v28, v27, 4, v26
v_mul_u32_u24 v27, 80, v27
v_add_u32 v26, v26, v27
v_add_f32 v20, v20, v24
v_add_f32 v22, v22, v25
s_lshl_b32 s44, s38, 6
s_add_u32 s44, s44, 161792
v_lshl_add_u32 v27, v26, 2, s44
s_lshl_b32 s44, s38, 7
s_add_u32 s44, s44, 162432
v_lshl_add_u32 v28, v28, 2, s44
s_mov_b64 s[64:65], exec
s_mov_b64 exec, 0xffffffff
ds_write_b32 v27, v20
ds_write_b32 v28, v22
s_mov_b64 exec, s[64:65]
s_waitcnt lgkmcnt(0)
s_barrier
s_and_b32 s37, s2, 7
s_bfe_u32 s36, s2, 0x30003
s_lshr_b32 s44, s2, 6
s_lshl_b32 s39, s37, 2
s_add_u32 s39, s39, s44
s_mov_b32 s28, s16
s_mov_b32 s29, s17
s_mov_b32 s30, 1835008
s_mov_b32 s31, 0x00020000
s_mov_b32 s32, s8
s_mov_b32 s33, s9
s_mov_b32 s34, 524288
s_mov_b32 s35, 0x00020000
v_and_b32 v48, 31, v0
v_lshlrev_b32 v49, 3, v48
s_lshl_b32 s44, s38, 9
s_add_u32 s44, s44, 159744
v_add_u32 v49, s44, v49
ds_read_b64 v[52:53], v49
ds_read_b64 v[54:55], v49 offset:256
v_lshlrev_b32 v48, 2, v48
v_add_u32 v50, 162432, v48
ds_read_b32 v56, v50 offset:0
ds_read_b32 v57, v50 offset:128
ds_read_b32 v58, v50 offset:256
ds_read_b32 v59, v50 offset:384
v_lshrrev_b32 v12, 5, v0
v_lshlrev_b32 v12, 5, v12
v_add_u32 v12, 161792, v12
v_lshlrev_b32 v13, 4, v0
v_bfe_u32 v51, v0, 4, 1
v_mul_u32_u24 v51, 256, v51
v_add_u32 v51, v51, v48
v_add_u32 v51, 162048, v51
s_waitcnt lgkmcnt(0)
v_add_f32 v56, v56, v57
v_add_f32 v58, v58, v59
v_mov_b32 v2, v52
v_mov_b32 v4, v53
v_mov_b32 v3, v54
v_mov_b32 v5, v55
v_add_f32 v56, v56, v58
s_mov_b32 s72, 0xbfb8aa3b
s_mov_b32 s73, 0x3fb8aa3b
ds_write_b32 v51, v56
v_mul_f32 v6, s72, v4
v_mul_f32 v8, s73, v4
v_mul_f32 v10, v4, v4
v_mul_f32 v7, s72, v5
v_mul_f32 v9, s73, v5
v_mul_f32 v11, v5, v5
v_rcp_f32 v10, v10
v_rcp_f32 v11, v11
v_mov_b32 v14, 0x3f317218
v_mov_b32 v15, 0x358637bd
s_lshl_b32 s51, s25, 3
s_lshl_b32 s45, s38, 1
s_add_u32 s51, s51, s45
s_cmp_eq_u32 s26, 1
s_cbranch_scc1 L_ep_b1
ds_read_b128 v[16:19], v12 offset:0
ds_read_b128 v[20:23], v12 offset:16
ds_read_b128 v[24:27], v12 offset:320
ds_read_b128 v[28:31], v12 offset:336
s_lshl_b32 s52, s27, 2
s_mul_i32 s45, s27, 5
s_add_u32 s45, s45, 64
s_cmp_eq_u32 s26, 2
s_cselect_b32 s52, s45, s52
s_add_u32 s45, s51, 0
s_mul_i32 s45, s45, 112
s_add_u32 s45, s45, s52
s_lshl_b32 s45, s45, 10
s_add_u32 s56, s22, s45
s_addc_u32 s57, s23, 0
s_add_u32 s45, s51, 1
s_mul_i32 s45, s45, 112
s_add_u32 s45, s45, s52
s_lshl_b32 s45, s45, 10
s_add_u32 s58, s22, s45
s_addc_u32 s59, s23, 0
s_waitcnt lgkmcnt(0)
ds_read_b128 v[32:35], v12 offset:64
ds_read_b128 v[36:39], v12 offset:80
ds_read_b128 v[40:43], v12 offset:384
ds_read_b128 v[44:47], v12 offset:400
v_pk_fma_f32 v[96:97], v[16:17], v[2:3], v[96:97] op_sel_hi:[1,0,1] neg_lo:[0,1,0] neg_hi:[0,1,0]
v_pk_fma_f32 v[98:99], v[18:19], v[2:3], v[98:99] op_sel_hi:[1,0,1] neg_lo:[0,1,0] neg_hi:[0,1,0]
v_pk_fma_f32 v[100:101], v[20:21], v[2:3], v[100:101] op_sel_hi:[1,0,1] neg_lo:[0,1,0] neg_hi:[0,1,0]
v_pk_fma_f32 v[102:103], v[22:23], v[2:3], v[102:103] op_sel_hi:[1,0,1] neg_lo:[0,1,0] neg_hi:[0,1,0]
v_pk_fma_f32 v[104:105], v[24:25], v[2:3], v[104:105] op_sel_hi:[1,0,1] neg_lo:[0,1,0] neg_hi:[0,1,0]
v_pk_fma_f32 v[106:107], v[26:27], v[2:3], v[106:107] op_sel_hi:[1,0,1] neg_lo:[0,1,0] neg_hi:[0,1,0]
v_pk_fma_f32 v[108:109], v[28:29], v[2:3], v[108:109] op_sel_hi:[1,0,1] neg_lo:[0,1,0] neg_hi:[0,1,0]
v_pk_fma_f32 v[110:111], v[30:31], v[2:3], v[110:111] op_sel_hi:[1,0,1] neg_lo:[0,1,0] neg_hi:[0,1,0]
v_pk_mul_f32 v[48:49], v[96:97], v[6:7] op_sel_hi:[1,0]
v_pk_mul_f32 v[50:51], v[98:99], v[6:7] op_sel_hi:[1,0]
v_pk_mul_f32 v[52:53], v[100:101], v[6:7] op_sel_hi:[1,0]
v_pk_mul_f32 v[54:55], v[102:103], v[6:7] op_sel_hi:[1,0]
v_pk_mul_f32 v[104:105], v[96:97], v[104:105]
v_pk_mul_f32 v[106:107], v[98:99], v[106:107]
v_pk_mul_f32 v[108:109], v[100:101], v[108:109]
v_pk_mul_f32 v[110:111], v[102:103], v[110:111]
v_exp_f32 v48, v48
v_exp_f32 v49, v49
v_exp_f32 v50, v50
v_exp_f32 v51, v51
v_exp_f32 v52, v52
v_exp_f32 v53, v53
v_exp_f32 v54, v54
v_exp_f32 v55, v55
v_pk_fma_f32 v[48:49], v[48:49], v[10:11], v[10:11] op_sel_hi:[1,0,0]
v_pk_fma_f32 v[50:51], v[50:51], v[10:11], v[10:11] op_sel_hi:[1,0,0]
v_pk_fma_f32 v[52:53], v[52:53], v[10:11], v[10:11] op_sel_hi:[1,0,0]
v_pk_fma_f32 v[54:55], v[54:55], v[10:11], v[10:11] op_sel_hi:[1,0,0]
v_rcp_f32 v48, v48
v_rcp_f32 v49, v49
v_rcp_f32 v50, v50
v_rcp_f32 v51, v51
v_rcp_f32 v52, v52
v_rcp_f32 v53, v53
v_rcp_f32 v54, v54
v_rcp_f32 v55, v55
v_pk_mul_f32 v[48:49], v[48:49], v[104:105]
v_pk_mul_f32 v[50:51], v[50:51], v[106:107]
v_pk_mul_f32 v[52:53], v[52:53], v[108:109]
v_pk_mul_f32 v[54:55], v[54:55], v[110:111]
v_cvt_pk_bf16_f32 v64, v48, v49
v_cvt_pk_bf16_f32 v65, v50, v51
v_cvt_pk_bf16_f32 v66, v52, v53
v_cvt_pk_bf16_f32 v67, v54, v55
global_store_dwordx4 v13, v[64:67], s[56:57] offset:0 sc1
v_pk_fma_f32 v[112:113], v[16:17], v[2:3], v[112:113] op_sel:[0,1,0] neg_lo:[0,1,0] neg_hi:[0,1,0]
v_pk_fma_f32 v[114:115], v[18:19], v[2:3], v[114:115] op_sel:[0,1,0] neg_lo:[0,1,0] neg_hi:[0,1,0]
v_pk_fma_f32 v[116:117], v[20:21], v[2:3], v[116:117] op_sel:[0,1,0] neg_lo:[0,1,0] neg_hi:[0,1,0]
v_pk_fma_f32 v[118:119], v[22:23], v[2:3], v[118:119] op_sel:[0,1,0] neg_lo:[0,1,0] neg_hi:[0,1,0]
v_pk_fma_f32 v[120:121], v[24:25], v[2:3], v[120:121] op_sel:[0,1,0] neg_lo:[0,1,0] neg_hi:[0,1,0]
v_pk_fma_f32 v[122:123], v[26:27], v[2:3], v[122:123] op_sel:[0,1,0] neg_lo:[0,1,0] neg_hi:[0,1,0]
v_pk_fma_f32 v[124:125], v[28:29], v[2:3], v[124:125] op_sel:[0,1,0] neg_lo:[0,1,0] neg_hi:[0,1,0]
v_pk_fma_f32 v[126:127], v[30:31], v[2:3], v[126:127] op_sel:[0,1,0] neg_lo:[0,1,0] neg_hi:[0,1,0]
v_pk_mul_f32 v[48:49], v[112:113], v[6:7] op_sel:[0,1]
v_pk_mul_f32 v[50:51], v[114:115], v[6:7] op_sel:[0,1]
v_pk_mul_f32 v[52:53], v[116:117], v[6:7] op_sel:[0,1]
v_pk_mul_f32 v[54:55], v[118:119], v[6:7] op_sel:[0,1]
v_pk_mul_f32 v[120:121], v[112:113], v[120:121]
v_pk_mul_f32 v[122:123], v[114:115], v[122:123]
v_pk_mul_f32 v[124:125], v[116:117], v[124:125]
v_pk_mul_f32 v[126:127], v[118:119], v[126:127]
v_exp_f32 v48, v48
v_exp_f32 v49, v49
v_exp_f32 v50, v50
v_exp_f32 v51, v51
v_exp_f32 v52, v52
v_exp_f32 v53, v53
v_exp_f32 v54, v54
v_exp_f32 v55, v55
v_pk_fma_f32 v[48:49], v[48:49], v[10:11], v[10:11] op_sel:[0,1,1]
v_pk_fma_f32 v[50:51], v[50:51], v[10:11], v[10:11] op_sel:[0,1,1]
v_pk_fma_f32 v[52:53], v[52:53], v[10:11], v[10:11] op_sel:[0,1,1]
v_pk_fma_f32 v[54:55], v[54:55], v[10:11], v[10:11] op_sel:[0,1,1]
v_rcp_f32 v48, v48
v_rcp_f32 v49, v49
v_rcp_f32 v50, v50
v_rcp_f32 v51, v51
v_rcp_f32 v52, v52
v_rcp_f32 v53, v53
v_rcp_f32 v54, v54
v_rcp_f32 v55, v55
v_pk_mul_f32 v[48:49], v[48:49], v[120:121]
v_pk_mul_f32 v[50:51], v[50:51], v[122:123]
v_pk_mul_f32 v[52:53], v[52:53], v[124:125]
v_pk_mul_f32 v[54:55], v[54:55], v[126:127]
v_cvt_pk_bf16_f32 v68, v48, v49
v_cvt_pk_bf16_f32 v69, v50, v51
v_cvt_pk_bf16_f32 v70, v52, v53
v_cvt_pk_bf16_f32 v71, v54, v55
global_store_dwordx4 v13, v[68:71], s[58:59] offset:0 sc1
s_waitcnt lgkmcnt(0)
ds_read_b128 v[16:19], v12 offset:128
ds_read_b128 v[20:23], v12 offset:144
ds_read_b128 v[24:27], v12 offset:448
ds_read_b128 v[28:31], v12 offset:464
v_pk_fma_f32 v[128:129], v[32:33], v[2:3], v[128:129] op_sel_hi:[1,0,1] neg_lo:[0,1,0] neg_hi:[0,1,0]
v_pk_fma_f32 v[130:131], v[34:35], v[2:3], v[130:131] op_sel_hi:[1,0,1] neg_lo:[0,1,0] neg_hi:[0,1,0]
v_pk_fma_f32 v[132:133], v[36:37], v[2:3], v[132:133] op_sel_hi:[1,0,1] neg_lo:[0,1,0] neg_hi:[0,1,0]
v_pk_fma_f32 v[134:135], v[38:39], v[2:3], v[134:135] op_sel_hi:[1,0,1] neg_lo:[0,1,0] neg_hi:[0,1,0]
v_pk_fma_f32 v[136:137], v[40:41], v[2:3], v[136:137] op_sel_hi:[1,0,1] neg_lo:[0,1,0] neg_hi:[0,1,0]
v_pk_fma_f32 v[138:139], v[42:43], v[2:3], v[138:139] op_sel_hi:[1,0,1] neg_lo:[0,1,0] neg_hi:[0,1,0]
v_pk_fma_f32 v[140:141], v[44:45], v[2:3], v[140:141] op_sel_hi:[1,0,1] neg_lo:[0,1,0] neg_hi:[0,1,0]
v_pk_fma_f32 v[142:143], v[46:47], v[2:3], v[142:143] op_sel_hi:[1,0,1] neg_lo:[0,1,0] neg_hi:[0,1,0]
v_pk_mul_f32 v[48:49], v[128:129], v[6:7] op_sel_hi:[1,0]
v_pk_mul_f32 v[50:51], v[130:131], v[6:7] op_sel_hi:[1,0]
v_pk_mul_f32 v[52:53], v[132:133], v[6:7] op_sel_hi:[1,0]
v_pk_mul_f32 v[54:55], v[134:135], v[6:7] op_sel_hi:[1,0]
v_pk_mul_f32 v[136:137], v[128:129], v[136:137]
v_pk_mul_f32 v[138:139], v[130:131], v[138:139]
v_pk_mul_f32 v[140:141], v[132:133], v[140:141]
v_pk_mul_f32 v[142:143], v[134:135], v[142:143]
v_exp_f32 v48, v48
v_exp_f32 v49, v49
v_exp_f32 v50, v50
v_exp_f32 v51, v51
v_exp_f32 v52, v52
v_exp_f32 v53, v53
v_exp_f32 v54, v54
v_exp_f32 v55, v55
v_pk_fma_f32 v[48:49], v[48:49], v[10:11], v[10:11] op_sel_hi:[1,0,0]
v_pk_fma_f32 v[50:51], v[50:51], v[10:11], v[10:11] op_sel_hi:[1,0,0]
v_pk_fma_f32 v[52:53], v[52:53], v[10:11], v[10:11] op_sel_hi:[1,0,0]
v_pk_fma_f32 v[54:55], v[54:55], v[10:11], v[10:11] op_sel_hi:[1,0,0]
v_rcp_f32 v48, v48
v_rcp_f32 v49, v49
v_rcp_f32 v50, v50
v_rcp_f32 v51, v51
v_rcp_f32 v52, v52
v_rcp_f32 v53, v53
v_rcp_f32 v54, v54
v_rcp_f32 v55, v55
v_pk_mul_f32 v[48:49], v[48:49], v[136:137]
v_pk_mul_f32 v[50:51], v[50:51], v[138:139]
v_pk_mul_f32 v[52:53], v[52:53], v[140:141]
v_pk_mul_f32 v[54:55], v[54:55], v[142:143]
v_cvt_pk_bf16_f32 v64, v48, v49
v_cvt_pk_bf16_f32 v65, v50, v51
v_cvt_pk_bf16_f32 v66, v52, v53
v_cvt_pk_bf16_f32 v67, v54, v55
global_store_dwordx4 v13, v[64:67], s[56:57] offset:1024 sc1
v_pk_fma_f32 v[144:145], v[32:33], v[2:3], v[144:145] op_sel:[0,1,0] neg_lo:[0,1,0] neg_hi:[0,1,0]
v_pk_fma_f32 v[146:147], v[34:35], v[2:3], v[146:147] op_sel:[0,1,0] neg_lo:[0,1,0] neg_hi:[0,1,0]
v_pk_fma_f32 v[148:149], v[36:37], v[2:3], v[148:149] op_sel:[0,1,0] neg_lo:[0,1,0] neg_hi:[0,1,0]
v_pk_fma_f32 v[150:151], v[38:39], v[2:3], v[150:151] op_sel:[0,1,0] neg_lo:[0,1,0] neg_hi:[0,1,0]
v_pk_fma_f32 v[152:153], v[40:41], v[2:3], v[152:153] op_sel:[0,1,0] neg_lo:[0,1,0] neg_hi:[0,1,0]
v_pk_fma_f32 v[154:155], v[42:43], v[2:3], v[154:155] op_sel:[0,1,0] neg_lo:[0,1,0] neg_hi:[0,1,0]
v_pk_fma_f32 v[156:157], v[44:45], v[2:3], v[156:157] op_sel:[0,1,0] neg_lo:[0,1,0] neg_hi:[0,1,0]
v_pk_fma_f32 v[158:159], v[46:47], v[2:3], v[158:159] op_sel:[0,1,0] neg_lo:[0,1,0] neg_hi:[0,1,0]
v_pk_mul_f32 v[48:49], v[144:145], v[6:7] op_sel:[0,1]
v_pk_mul_f32 v[50:51], v[146:147], v[6:7] op_sel:[0,1]
v_pk_mul_f32 v[52:53], v[148:149], v[6:7] op_sel:[0,1]
v_pk_mul_f32 v[54:55], v[150:151], v[6:7] op_sel:[0,1]
v_pk_mul_f32 v[152:153], v[144:145], v[152:153]
v_pk_mul_f32 v[154:155], v[146:147], v[154:155]
v_pk_mul_f32 v[156:157], v[148:149], v[156:157]
v_pk_mul_f32 v[158:159], v[150:151], v[158:159]
v_exp_f32 v48, v48
v_exp_f32 v49, v49
v_exp_f32 v50, v50
v_exp_f32 v51, v51
v_exp_f32 v52, v52
v_exp_f32 v53, v53
v_exp_f32 v54, v54
v_exp_f32 v55, v55
v_pk_fma_f32 v[48:49], v[48:49], v[10:11], v[10:11] op_sel:[0,1,1]
v_pk_fma_f32 v[50:51], v[50:51], v[10:11], v[10:11] op_sel:[0,1,1]
v_pk_fma_f32 v[52:53], v[52:53], v[10:11], v[10:11] op_sel:[0,1,1]
v_pk_fma_f32 v[54:55], v[54:55], v[10:11], v[10:11] op_sel:[0,1,1]
v_rcp_f32 v48, v48
v_rcp_f32 v49, v49
v_rcp_f32 v50, v50
v_rcp_f32 v51, v51
v_rcp_f32 v52, v52
v_rcp_f32 v53, v53
v_rcp_f32 v54, v54
v_rcp_f32 v55, v55
v_pk_mul_f32 v[48:49], v[48:49], v[152:153]
v_pk_mul_f32 v[50:51], v[50:51], v[154:155]
v_pk_mul_f32 v[52:53], v[52:53], v[156:157]
v_pk_mul_f32 v[54:55], v[54:55], v[158:159]
v_cvt_pk_bf16_f32 v68, v48, v49
v_cvt_pk_bf16_f32 v69, v50, v51
v_cvt_pk_bf16_f32 v70, v52, v53
v_cvt_pk_bf16_f32 v71, v54, v55
global_store_dwordx4 v13, v[68:71], s[58:59] offset:1024 sc1
s_waitcnt lgkmcnt(0)
ds_read_b128 v[32:35], v12 offset:192
ds_read_b128 v[36:39], v12 offset:208
ds_read_b128 v[40:43], v12 offset:512
ds_read_b128 v[44:47], v12 offset:528
v_pk_fma_f32 v[160:161], v[16:17], v[2:3], v[160:161] op_sel_hi:[1,0,1] neg_lo:[0,1,0] neg_hi:[0,1,0]
v_pk_fma_f32 v[162:163], v[18:19], v[2:3], v[162:163] op_sel_hi:[1,0,1] neg_lo:[0,1,0] neg_hi:[0,1,0]
v_pk_fma_f32 v[164:165], v[20:21], v[2:3], v[164:165] op_sel_hi:[1,0,1] neg_lo:[0,1,0] neg_hi:[0,1,0]
v_pk_fma_f32 v[166:167], v[22:23], v[2:3], v[166:167] op_sel_hi:[1,0,1] neg_lo:[0,1,0] neg_hi:[0,1,0]
v_pk_fma_f32 v[168:169], v[24:25], v[2:3], v[168:169] op_sel_hi:[1,0,1] neg_lo:[0,1,0] neg_hi:[0,1,0]
v_pk_fma_f32 v[170:171], v[26:27], v[2:3], v[170:171] op_sel_hi:[1,0,1] neg_lo:[0,1,0] neg_hi:[0,1,0]
v_pk_fma_f32 v[172:173], v[28:29], v[2:3], v[172:173] op_sel_hi:[1,0,1] neg_lo:[0,1,0] neg_hi:[0,1,0]
v_pk_fma_f32 v[174:175], v[30:31], v[2:3], v[174:175] op_sel_hi:[1,0,1] neg_lo:[0,1,0] neg_hi:[0,1,0]
v_pk_mul_f32 v[48:49], v[160:161], v[6:7] op_sel_hi:[1,0]
v_pk_mul_f32 v[50:51], v[162:163], v[6:7] op_sel_hi:[1,0]
v_pk_mul_f32 v[52:53], v[164:165], v[6:7] op_sel_hi:[1,0]
v_pk_mul_f32 v[54:55], v[166:167], v[6:7] op_sel_hi:[1,0]
v_pk_mul_f32 v[168:169], v[160:161], v[168:169]
v_pk_mul_f32 v[170:171], v[162:163], v[170:171]
v_pk_mul_f32 v[172:173], v[164:165], v[172:173]
v_pk_mul_f32 v[174:175], v[166:167], v[174:175]
v_exp_f32 v48, v48
v_exp_f32 v49, v49
v_exp_f32 v50, v50
v_exp_f32 v51, v51
v_exp_f32 v52, v52
v_exp_f32 v53, v53
v_exp_f32 v54, v54
v_exp_f32 v55, v55
v_pk_fma_f32 v[48:49], v[48:49], v[10:11], v[10:11] op_sel_hi:[1,0,0]
v_pk_fma_f32 v[50:51], v[50:51], v[10:11], v[10:11] op_sel_hi:[1,0,0]
v_pk_fma_f32 v[52:53], v[52:53], v[10:11], v[10:11] op_sel_hi:[1,0,0]
v_pk_fma_f32 v[54:55], v[54:55], v[10:11], v[10:11] op_sel_hi:[1,0,0]
v_rcp_f32 v48, v48
v_rcp_f32 v49, v49
v_rcp_f32 v50, v50
v_rcp_f32 v51, v51
v_rcp_f32 v52, v52
v_rcp_f32 v53, v53
v_rcp_f32 v54, v54
v_rcp_f32 v55, v55
v_pk_mul_f32 v[48:49], v[48:49], v[168:169]
v_pk_mul_f32 v[50:51], v[50:51], v[170:171]
v_pk_mul_f32 v[52:53], v[52:53], v[172:173]
v_pk_mul_f32 v[54:55], v[54:55], v[174:175]
v_cvt_pk_bf16_f32 v64, v48, v49
v_cvt_pk_bf16_f32 v65, v50, v51
v_cvt_pk_bf16_f32 v66, v52, v53
v_cvt_pk_bf16_f32 v67, v54, v55
global_store_dwordx4 v13, v[64:67], s[56:57] offset:2048 sc1
v_pk_fma_f32 v[176:177], v[16:17], v[2:3], v[176:177] op_sel:[0,1,0] neg_lo:[0,1,0] neg_hi:[0,1,0]
v_pk_fma_f32 v[178:179], v[18:19], v[2:3], v[178:179] op_sel:[0,1,0] neg_lo:[0,1,0] neg_hi:[0,1,0]
v_pk_fma_f32 v[180:181], v[20:21], v[2:3], v[180:181] op_sel:[0,1,0] neg_lo:[0,1,0] neg_hi:[0,1,0]
v_pk_fma_f32 v[182:183], v[22:23], v[2:3], v[182:183] op_sel:[0,1,0] neg_lo:[0,1,0] neg_hi:[0,1,0]
v_pk_fma_f32 v[184:185], v[24:25], v[2:3], v[184:185] op_sel:[0,1,0] neg_lo:[0,1,0] neg_hi:[0,1,0]
v_pk_fma_f32 v[186:187], v[26:27], v[2:3], v[186:187] op_sel:[0,1,0] neg_lo:[0,1,0] neg_hi:[0,1,0]
v_pk_fma_f32 v[188:189], v[28:29], v[2:3], v[188:189] op_sel:[0,1,0] neg_lo:[0,1,0] neg_hi:[0,1,0]
v_pk_fma_f32 v[190:191], v[30:31], v[2:3], v[190:191] op_sel:[0,1,0] neg_lo:[0,1,0] neg_hi:[0,1,0]
v_pk_mul_f32 v[48:49], v[176:177], v[6:7] op_sel:[0,1]
v_pk_mul_f32 v[50:51], v[178:179], v[6:7] op_sel:[0,1]
v_pk_mul_f32 v[52:53], v[180:181], v[6:7] op_sel:[0,1]
v_pk_mul_f32 v[54:55], v[182:183], v[6:7] op_sel:[0,1]
v_pk_mul_f32 v[184:185], v[176:177], v[184:185]
v_pk_mul_f32 v[186:187], v[178:179], v[186:187]
v_pk_mul_f32 v[188:189], v[180:181], v[188:189]
v_pk_mul_f32 v[190:191], v[182:183], v[190:191]
v_exp_f32 v48, v48
v_exp_f32 v49, v49
v_exp_f32 v50, v50
v_exp_f32 v51, v51
v_exp_f32 v52, v52
v_exp_f32 v53, v53
v_exp_f32 v54, v54
v_exp_f32 v55, v55
v_pk_fma_f32 v[48:49], v[48:49], v[10:11], v[10:11] op_sel:[0,1,1]
v_pk_fma_f32 v[50:51], v[50:51], v[10:11], v[10:11] op_sel:[0,1,1]
v_pk_fma_f32 v[52:53], v[52:53], v[10:11], v[10:11] op_sel:[0,1,1]
v_pk_fma_f32 v[54:55], v[54:55], v[10:11], v[10:11] op_sel:[0,1,1]
v_rcp_f32 v48, v48
v_rcp_f32 v49, v49
v_rcp_f32 v50, v50
v_rcp_f32 v51, v51
v_rcp_f32 v52, v52
v_rcp_f32 v53, v53
v_rcp_f32 v54, v54
v_rcp_f32 v55, v55
v_pk_mul_f32 v[48:49], v[48:49], v[184:185]
v_pk_mul_f32 v[50:51], v[50:51], v[186:187]
v_pk_mul_f32 v[52:53], v[52:53], v[188:189]
v_pk_mul_f32 v[54:55], v[54:55], v[190:191]
v_cvt_pk_bf16_f32 v68, v48, v49
v_cvt_pk_bf16_f32 v69, v50, v51
v_cvt_pk_bf16_f32 v70, v52, v53
v_cvt_pk_bf16_f32 v71, v54, v55
global_store_dwordx4 v13, v[68:71], s[58:59] offset:2048 sc1
s_waitcnt lgkmcnt(0)
ds_read_b128 v[16:19], v12 offset:256
ds_read_b128 v[20:23], v12 offset:272
ds_read_b128 v[24:27], v12 offset:576
ds_read_b128 v[28:31], v12 offset:592
v_pk_fma_f32 v[192:193], v[32:33], v[2:3], v[192:193] op_sel_hi:[1,0,1] neg_lo:[0,1,0] neg_hi:[0,1,0]
v_pk_fma_f32 v[194:195], v[34:35], v[2:3], v[194:195] op_sel_hi:[1,0,1] neg_lo:[0,1,0] neg_hi:[0,1,0]
v_pk_fma_f32 v[196:197], v[36:37], v[2:3], v[196:197] op_sel_hi:[1,0,1] neg_lo:[0,1,0] neg_hi:[0,1,0]
v_pk_fma_f32 v[198:199], v[38:39], v[2:3], v[198:199] op_sel_hi:[1,0,1] neg_lo:[0,1,0] neg_hi:[0,1,0]
v_pk_fma_f32 v[200:201], v[40:41], v[2:3], v[200:201] op_sel_hi:[1,0,1] neg_lo:[0,1,0] neg_hi:[0,1,0]
v_pk_fma_f32 v[202:203], v[42:43], v[2:3], v[202:203] op_sel_hi:[1,0,1] neg_lo:[0,1,0] neg_hi:[0,1,0]
v_pk_fma_f32 v[204:205], v[44:45], v[2:3], v[204:205] op_sel_hi:[1,0,1] neg_lo:[0,1,0] neg_hi:[0,1,0]
v_pk_fma_f32 v[206:207], v[46:47], v[2:3], v[206:207] op_sel_hi:[1,0,1] neg_lo:[0,1,0] neg_hi:[0,1,0]
v_pk_mul_f32 v[48:49], v[192:193], v[6:7] op_sel_hi:[1,0]
v_pk_mul_f32 v[50:51], v[194:195], v[6:7] op_sel_hi:[1,0]
v_pk_mul_f32 v[52:53], v[196:197], v[6:7] op_sel_hi:[1,0]
v_pk_mul_f32 v[54:55], v[198:199], v[6:7] op_sel_hi:[1,0]
v_pk_mul_f32 v[200:201], v[192:193], v[200:201]
v_pk_mul_f32 v[202:203], v[194:195], v[202:203]
v_pk_mul_f32 v[204:205], v[196:197], v[204:205]
v_pk_mul_f32 v[206:207], v[198:199], v[206:207]
v_exp_f32 v48, v48
v_exp_f32 v49, v49
v_exp_f32 v50, v50
v_exp_f32 v51, v51
v_exp_f32 v52, v52
v_exp_f32 v53, v53
v_exp_f32 v54, v54
v_exp_f32 v55, v55
v_pk_fma_f32 v[48:49], v[48:49], v[10:11], v[10:11] op_sel_hi:[1,0,0]
v_pk_fma_f32 v[50:51], v[50:51], v[10:11], v[10:11] op_sel_hi:[1,0,0]
v_pk_fma_f32 v[52:53], v[52:53], v[10:11], v[10:11] op_sel_hi:[1,0,0]
v_pk_fma_f32 v[54:55], v[54:55], v[10:11], v[10:11] op_sel_hi:[1,0,0]
v_rcp_f32 v48, v48
v_rcp_f32 v49, v49
v_rcp_f32 v50, v50
v_rcp_f32 v51, v51
v_rcp_f32 v52, v52
v_rcp_f32 v53, v53
v_rcp_f32 v54, v54
v_rcp_f32 v55, v55
v_pk_mul_f32 v[48:49], v[48:49], v[200:201]
v_pk_mul_f32 v[50:51], v[50:51], v[202:203]
v_pk_mul_f32 v[52:53], v[52:53], v[204:205]
v_pk_mul_f32 v[54:55], v[54:55], v[206:207]
v_cvt_pk_bf16_f32 v64, v48, v49
v_cvt_pk_bf16_f32 v65, v50, v51
v_cvt_pk_bf16_f32 v66, v52, v53
v_cvt_pk_bf16_f32 v67, v54, v55
global_store_dwordx4 v13, v[64:67], s[56:57] offset:3072 sc1
v_pk_fma_f32 v[208:209], v[32:33], v[2:3], v[208:209] op_sel:[0,1,0] neg_lo:[0,1,0] neg_hi:[0,1,0]
v_pk_fma_f32 v[210:211], v[34:35], v[2:3], v[210:211] op_sel:[0,1,0] neg_lo:[0,1,0] neg_hi:[0,1,0]
v_pk_fma_f32 v[212:213], v[36:37], v[2:3], v[212:213] op_sel:[0,1,0] neg_lo:[0,1,0] neg_hi:[0,1,0]
v_pk_fma_f32 v[214:215], v[38:39], v[2:3], v[214:215] op_sel:[0,1,0] neg_lo:[0,1,0] neg_hi:[0,1,0]
v_pk_fma_f32 v[216:217], v[40:41], v[2:3], v[216:217] op_sel:[0,1,0] neg_lo:[0,1,0] neg_hi:[0,1,0]
v_pk_fma_f32 v[218:219], v[42:43], v[2:3], v[218:219] op_sel:[0,1,0] neg_lo:[0,1,0] neg_hi:[0,1,0]
v_pk_fma_f32 v[220:221], v[44:45], v[2:3], v[220:221] op_sel:[0,1,0] neg_lo:[0,1,0] neg_hi:[0,1,0]
v_pk_fma_f32 v[222:223], v[46:47], v[2:3], v[222:223] op_sel:[0,1,0] neg_lo:[0,1,0] neg_hi:[0,1,0]
v_pk_mul_f32 v[48:49], v[208:209], v[6:7] op_sel:[0,1]
v_pk_mul_f32 v[50:51], v[210:211], v[6:7] op_sel:[0,1]
v_pk_mul_f32 v[52:53], v[212:213], v[6:7] op_sel:[0,1]
v_pk_mul_f32 v[54:55], v[214:215], v[6:7] op_sel:[0,1]
v_pk_mul_f32 v[216:217], v[208:209], v[216:217]
v_pk_mul_f32 v[218:219], v[210:211], v[218:219]
v_pk_mul_f32 v[220:221], v[212:213], v[220:221]
v_pk_mul_f32 v[222:223], v[214:215], v[222:223]
v_exp_f32 v48, v48
v_exp_f32 v49, v49
v_exp_f32 v50, v50
v_exp_f32 v51, v51
v_exp_f32 v52, v52
v_exp_f32 v53, v53
v_exp_f32 v54, v54
v_exp_f32 v55, v55
v_pk_fma_f32 v[48:49], v[48:49], v[10:11], v[10:11] op_sel:[0,1,1]
v_pk_fma_f32 v[50:51], v[50:51], v[10:11], v[10:11] op_sel:[0,1,1]
v_pk_fma_f32 v[52:53], v[52:53], v[10:11], v[10:11] op_sel:[0,1,1]
v_pk_fma_f32 v[54:55], v[54:55], v[10:11], v[10:11] op_sel:[0,1,1]
v_rcp_f32 v48, v48
v_rcp_f32 v49, v49
v_rcp_f32 v50, v50
v_rcp_f32 v51, v51
v_rcp_f32 v52, v52
v_rcp_f32 v53, v53
v_rcp_f32 v54, v54
v_rcp_f32 v55, v55
v_pk_mul_f32 v[48:49], v[48:49], v[216:217]
v_pk_mul_f32 v[50:51], v[50:51], v[218:219]
v_pk_mul_f32 v[52:53], v[52:53], v[220:221]
v_pk_mul_f32 v[54:55], v[54:55], v[222:223]
v_cvt_pk_bf16_f32 v68, v48, v49
v_cvt_pk_bf16_f32 v69, v50, v51
v_cvt_pk_bf16_f32 v70, v52, v53
v_cvt_pk_bf16_f32 v71, v54, v55
global_store_dwordx4 v13, v[68:71], s[58:59] offset:3072 sc1
s_cmp_eq_u32 s26, 2
s_cbranch_scc1 L_ep_f4b2
s_add_u32 s45, s51, 0
s_lshl_b32 s45, s45, 5
s_lshl_b32 s46, s27, 1
s_add_u32 s45, s45, s46
s_lshl_b32 s45, s45, 10
s_add_u32 s45, s45, 7340032
s_add_u32 s60, s22, s45
s_addc_u32 s61, s23, 0
s_add_u32 s45, s51, 1
s_lshl_b32 s45, s45, 5
s_lshl_b32 s46, s27, 1
s_add_u32 s45, s45, s46
s_lshl_b32 s45, s45, 10
s_add_u32 s45, s45, 7340032
s_add_u32 s62, s22, s45
s_addc_u32 s63, s23, 0
s_waitcnt lgkmcnt(0)
v_pk_fma_f32 v[224:225], v[16:17], v[2:3], v[224:225] op_sel_hi:[1,0,1] neg_lo:[0,1,0] neg_hi:[0,1,0]
v_pk_fma_f32 v[226:227], v[18:19], v[2:3], v[226:227] op_sel_hi:[1,0,1] neg_lo:[0,1,0] neg_hi:[0,1,0]
v_pk_fma_f32 v[228:229], v[20:21], v[2:3], v[228:229] op_sel_hi:[1,0,1] neg_lo:[0,1,0] neg_hi:[0,1,0]
v_pk_fma_f32 v[230:231], v[22:23], v[2:3], v[230:231] op_sel_hi:[1,0,1] neg_lo:[0,1,0] neg_hi:[0,1,0]
v_pk_fma_f32 v[232:233], v[24:25], v[2:3], v[232:233] op_sel_hi:[1,0,1] neg_lo:[0,1,0] neg_hi:[0,1,0]
v_pk_fma_f32 v[234:235], v[26:27], v[2:3], v[234:235] op_sel_hi:[1,0,1] neg_lo:[0,1,0] neg_hi:[0,1,0]
v_pk_fma_f32 v[236:237], v[28:29], v[2:3], v[236:237] op_sel_hi:[1,0,1] neg_lo:[0,1,0] neg_hi:[0,1,0]
v_pk_fma_f32 v[238:239], v[30:31], v[2:3], v[238:239] op_sel_hi:[1,0,1] neg_lo:[0,1,0] neg_hi:[0,1,0]
v_pk_mul_f32 v[224:225], v[224:225], v[8:9] op_sel_hi:[1,0]
v_pk_mul_f32 v[226:227], v[226:227], v[8:9] op_sel_hi:[1,0]
v_pk_mul_f32 v[228:229], v[228:229], v[8:9] op_sel_hi:[1,0]
v_pk_mul_f32 v[230:231], v[230:231], v[8:9] op_sel_hi:[1,0]
v_min_f32 v48, 0, v224
v_min_f32 v49, 0, v225
v_min_f32 v50, 0, v226
v_min_f32 v51, 0, v227
v_min_f32 v52, 0, v228
v_min_f32 v53, 0, v229
v_min_f32 v54, 0, v230
v_min_f32 v55, 0, v231
v_pk_add_f32 v[224:225], v[224:225], v[48:49] neg_lo:[0,1] neg_hi:[0,1]
v_pk_add_f32 v[226:227], v[226:227], v[50:51] neg_lo:[0,1] neg_hi:[0,1]
v_pk_add_f32 v[228:229], v[228:229], v[52:53] neg_lo:[0,1] neg_hi:[0,1]
v_pk_add_f32 v[230:231], v[230:231], v[54:55] neg_lo:[0,1] neg_hi:[0,1]
v_exp_f32 v48, v48
v_exp_f32 v49, v49
v_exp_f32 v50, v50
v_exp_f32 v51, v51
v_exp_f32 v52, v52
v_exp_f32 v53, v53
v_exp_f32 v54, v54
v_exp_f32 v55, v55
v_pk_fma_f32 v[224:225], v[224:225], v[14:15], v[14:15] op_sel:[0,0,1] op_sel_hi:[1,0,1]
v_pk_fma_f32 v[226:227], v[226:227], v[14:15], v[14:15] op_sel:[0,0,1] op_sel_hi:[1,0,1]
v_pk_fma_f32 v[228:229], v[228:229], v[14:15], v[14:15] op_sel:[0,0,1] op_sel_hi:[1,0,1]
v_pk_fma_f32 v[230:231], v[230:231], v[14:15], v[14:15] op_sel:[0,0,1] op_sel_hi:[1,0,1]
v_pk_add_f32 v[224:225], v[224:225], v[48:49]
v_pk_add_f32 v[226:227], v[226:227], v[50:51]
v_pk_add_f32 v[228:229], v[228:229], v[52:53]
v_pk_add_f32 v[230:231], v[230:231], v[54:55]
v_cvt_pk_bf16_f32 v64, v224, v225
v_cvt_pk_bf16_f32 v65, v226, v227
v_cvt_pk_bf16_f32 v66, v228, v229
v_cvt_pk_bf16_f32 v67, v230, v231
global_store_dwordx4 v13, v[64:67], s[60:61] offset:0 sc1
v_pk_mul_f32 v[232:233], v[232:233], v[8:9] op_sel_hi:[1,0]
v_pk_mul_f32 v[234:235], v[234:235], v[8:9] op_sel_hi:[1,0]
v_pk_mul_f32 v[236:237], v[236:237], v[8:9] op_sel_hi:[1,0]
v_pk_mul_f32 v[238:239], v[238:239], v[8:9] op_sel_hi:[1,0]
v_min_f32 v48, 0, v232
v_min_f32 v49, 0, v233
v_min_f32 v50, 0, v234
v_min_f32 v51, 0, v235
v_min_f32 v52, 0, v236
v_min_f32 v53, 0, v237
v_min_f32 v54, 0, v238
v_min_f32 v55, 0, v239
v_pk_add_f32 v[232:233], v[232:233], v[48:49] neg_lo:[0,1] neg_hi:[0,1]
v_pk_add_f32 v[234:235], v[234:235], v[50:51] neg_lo:[0,1] neg_hi:[0,1]
v_pk_add_f32 v[236:237], v[236:237], v[52:53] neg_lo:[0,1] neg_hi:[0,1]
v_pk_add_f32 v[238:239], v[238:239], v[54:55] neg_lo:[0,1] neg_hi:[0,1]
v_exp_f32 v48, v48
v_exp_f32 v49, v49
v_exp_f32 v50, v50
v_exp_f32 v51, v51
v_exp_f32 v52, v52
v_exp_f32 v53, v53
v_exp_f32 v54, v54
v_exp_f32 v55, v55
v_pk_fma_f32 v[232:233], v[232:233], v[14:15], v[14:15] op_sel:[0,0,1] op_sel_hi:[1,0,1]
v_pk_fma_f32 v[234:235], v[234:235], v[14:15], v[14:15] op_sel:[0,0,1] op_sel_hi:[1,0,1]
v_pk_fma_f32 v[236:237], v[236:237], v[14:15], v[14:15] op_sel:[0,0,1] op_sel_hi:[1,0,1]
v_pk_fma_f32 v[238:239], v[238:239], v[14:15], v[14:15] op_sel:[0,0,1] op_sel_hi:[1,0,1]
v_pk_add_f32 v[232:233], v[232:233], v[48:49]
v_pk_add_f32 v[234:235], v[234:235], v[50:51]
v_pk_add_f32 v[236:237], v[236:237], v[52:53]
v_pk_add_f32 v[238:239], v[238:239], v[54:55]
v_cvt_pk_bf16_f32 v68, v232, v233
v_cvt_pk_bf16_f32 v69, v234, v235
v_cvt_pk_bf16_f32 v70, v236, v237
v_cvt_pk_bf16_f32 v71, v238, v239
global_store_dwordx4 v13, v[68:71], s[60:61] offset:1024 sc1
v_pk_fma_f32 v[240:241], v[16:17], v[2:3], v[240:241] op_sel:[0,1,0] neg_lo:[0,1,0] neg_hi:[0,1,0]
v_pk_fma_f32 v[242:243], v[18:19], v[2:3], v[242:243] op_sel:[0,1,0] neg_lo:[0,1,0] neg_hi:[0,1,0]
v_pk_fma_f32 v[244:245], v[20:21], v[2:3], v[244:245] op_sel:[0,1,0] neg_lo:[0,1,0] neg_hi:[0,1,0]
v_pk_fma_f32 v[246:247], v[22:23], v[2:3], v[246:247] op_sel:[0,1,0] neg_lo:[0,1,0] neg_hi:[0,1,0]
v_pk_fma_f32 v[248:249], v[24:25], v[2:3], v[248:249] op_sel:[0,1,0] neg_lo:[0,1,0] neg_hi:[0,1,0]
v_pk_fma_f32 v[250:251], v[26:27], v[2:3], v[250:251] op_sel:[0,1,0] neg_lo:[0,1,0] neg_hi:[0,1,0]
v_pk_fma_f32 v[252:253], v[28:29], v[2:3], v[252:253] op_sel:[0,1,0] neg_lo:[0,1,0] neg_hi:[0,1,0]
v_pk_fma_f32 v[254:255], v[30:31], v[2:3], v[254:255] op_sel:[0,1,0] neg_lo:[0,1,0] neg_hi:[0,1,0]
v_pk_mul_f32 v[240:241], v[240:241], v[8:9] op_sel:[0,1]
v_pk_mul_f32 v[242:243], v[242:243], v[8:9] op_sel:[0,1]
v_pk_mul_f32 v[244:245], v[244:245], v[8:9] op_sel:[0,1]
v_pk_mul_f32 v[246:247], v[246:247], v[8:9] op_sel:[0,1]
v_min_f32 v48, 0, v240
v_min_f32 v49, 0, v241
v_min_f32 v50, 0, v242
v_min_f32 v51, 0, v243
v_min_f32 v52, 0, v244
v_min_f32 v53, 0, v245
v_min_f32 v54, 0, v246
v_min_f32 v55, 0, v247
v_pk_add_f32 v[240:241], v[240:241], v[48:49] neg_lo:[0,1] neg_hi:[0,1]
v_pk_add_f32 v[242:243], v[242:243], v[50:51] neg_lo:[0,1] neg_hi:[0,1]
v_pk_add_f32 v[244:245], v[244:245], v[52:53] neg_lo:[0,1] neg_hi:[0,1]
v_pk_add_f32 v[246:247], v[246:247], v[54:55] neg_lo:[0,1] neg_hi:[0,1]
v_exp_f32 v48, v48
v_exp_f32 v49, v49
v_exp_f32 v50, v50
v_exp_f32 v51, v51
v_exp_f32 v52, v52
v_exp_f32 v53, v53
v_exp_f32 v54, v54
v_exp_f32 v55, v55
v_pk_fma_f32 v[240:241], v[240:241], v[14:15], v[14:15] op_sel:[0,0,1] op_sel_hi:[1,0,1]
v_pk_fma_f32 v[242:243], v[242:243], v[14:15], v[14:15] op_sel:[0,0,1] op_sel_hi:[1,0,1]
v_pk_fma_f32 v[244:245], v[244:245], v[14:15], v[14:15] op_sel:[0,0,1] op_sel_hi:[1,0,1]
v_pk_fma_f32 v[246:247], v[246:247], v[14:15], v[14:15] op_sel:[0,0,1] op_sel_hi:[1,0,1]
v_pk_add_f32 v[240:241], v[240:241], v[48:49]
v_pk_add_f32 v[242:243], v[242:243], v[50:51]
v_pk_add_f32 v[244:245], v[244:245], v[52:53]
v_pk_add_f32 v[246:247], v[246:247], v[54:55]
v_cvt_pk_bf16_f32 v64, v240, v241
v_cvt_pk_bf16_f32 v65, v242, v243
v_cvt_pk_bf16_f32 v66, v244, v245
v_cvt_pk_bf16_f32 v67, v246, v247
global_store_dwordx4 v13, v[64:67], s[62:63] offset:0 sc1
v_pk_mul_f32 v[248:249], v[248:249], v[8:9] op_sel:[0,1]
v_pk_mul_f32 v[250:251], v[250:251], v[8:9] op_sel:[0,1]
v_pk_mul_f32 v[252:253], v[252:253], v[8:9] op_sel:[0,1]
v_pk_mul_f32 v[254:255], v[254:255], v[8:9] op_sel:[0,1]
v_min_f32 v48, 0, v248
v_min_f32 v49, 0, v249
v_min_f32 v50, 0, v250
v_min_f32 v51, 0, v251
v_min_f32 v52, 0, v252
v_min_f32 v53, 0, v253
v_min_f32 v54, 0, v254
v_min_f32 v55, 0, v255
v_pk_add_f32 v[248:249], v[248:249], v[48:49] neg_lo:[0,1] neg_hi:[0,1]
v_pk_add_f32 v[250:251], v[250:251], v[50:51] neg_lo:[0,1] neg_hi:[0,1]
v_pk_add_f32 v[252:253], v[252:253], v[52:53] neg_lo:[0,1] neg_hi:[0,1]
v_pk_add_f32 v[254:255], v[254:255], v[54:55] neg_lo:[0,1] neg_hi:[0,1]
v_exp_f32 v48, v48
v_exp_f32 v49, v49
v_exp_f32 v50, v50
v_exp_f32 v51, v51
v_exp_f32 v52, v52
v_exp_f32 v53, v53
v_exp_f32 v54, v54
v_exp_f32 v55, v55
v_pk_fma_f32 v[248:249], v[248:249], v[14:15], v[14:15] op_sel:[0,0,1] op_sel_hi:[1,0,1]
v_pk_fma_f32 v[250:251], v[250:251], v[14:15], v[14:15] op_sel:[0,0,1] op_sel_hi:[1,0,1]
v_pk_fma_f32 v[252:253], v[252:253], v[14:15], v[14:15] op_sel:[0,0,1] op_sel_hi:[1,0,1]
v_pk_fma_f32 v[254:255], v[254:255], v[14:15], v[14:15] op_sel:[0,0,1] op_sel_hi:[1,0,1]
v_pk_add_f32 v[248:249], v[248:249], v[48:49]
v_pk_add_f32 v[250:251], v[250:251], v[50:51]
v_pk_add_f32 v[252:253], v[252:253], v[52:53]
v_pk_add_f32 v[254:255], v[254:255], v[54:55]
v_cvt_pk_bf16_f32 v68, v248, v249
v_cvt_pk_bf16_f32 v69, v250, v251
v_cvt_pk_bf16_f32 v70, v252, v253
v_cvt_pk_bf16_f32 v71, v254, v255
global_store_dwordx4 v13, v[68:71], s[62:63] offset:1024 sc1
s_branch L_ep_flag
L_ep_f4b2:
s_add_u32 s52, s52, 4
s_add_u32 s45, s51, 0
s_mul_i32 s45, s45, 112
s_add_u32 s45, s45, s52
s_lshl_b32 s45, s45, 10
s_add_u32 s60, s22, s45
s_addc_u32 s61, s23, 0
s_add_u32 s45, s51, 1
s_mul_i32 s45, s45, 112
s_add_u32 s45, s45, s52
s_lshl_b32 s45, s45, 10
s_add_u32 s62, s22, s45
s_addc_u32 s63, s23, 0
s_waitcnt lgkmcnt(0)
v_pk_fma_f32 v[224:225], v[16:17], v[2:3], v[224:225] op_sel_hi:[1,0,1] neg_lo:[0,1,0] neg_hi:[0,1,0]
v_pk_fma_f32 v[226:227], v[18:19], v[2:3], v[226:227] op_sel_hi:[1,0,1] neg_lo:[0,1,0] neg_hi:[0,1,0]
v_pk_fma_f32 v[228:229], v[20:21], v[2:3], v[228:229] op_sel_hi:[1,0,1] neg_lo:[0,1,0] neg_hi:[0,1,0]
v_pk_fma_f32 v[230:231], v[22:23], v[2:3], v[230:231] op_sel_hi:[1,0,1] neg_lo:[0,1,0] neg_hi:[0,1,0]
v_pk_fma_f32 v[232:233], v[24:25], v[2:3], v[232:233] op_sel_hi:[1,0,1] neg_lo:[0,1,0] neg_hi:[0,1,0]
v_pk_fma_f32 v[234:235], v[26:27], v[2:3], v[234:235] op_sel_hi:[1,0,1] neg_lo:[0,1,0] neg_hi:[0,1,0]
v_pk_fma_f32 v[236:237], v[28:29], v[2:3], v[236:237] op_sel_hi:[1,0,1] neg_lo:[0,1,0] neg_hi:[0,1,0]
v_pk_fma_f32 v[238:239], v[30:31], v[2:3], v[238:239] op_sel_hi:[1,0,1] neg_lo:[0,1,0] neg_hi:[0,1,0]
v_pk_mul_f32 v[48:49], v[224:225], v[6:7] op_sel_hi:[1,0]
v_pk_mul_f32 v[50:51], v[226:227], v[6:7] op_sel_hi:[1,0]
v_pk_mul_f32 v[52:53], v[228:229], v[6:7] op_sel_hi:[1,0]
v_pk_mul_f32 v[54:55], v[230:231], v[6:7] op_sel_hi:[1,0]
v_pk_mul_f32 v[232:233], v[224:225], v[232:233]
v_pk_mul_f32 v[234:235], v[226:227], v[234:235]
v_pk_mul_f32 v[236:237], v[228:229], v[236:237]
v_pk_mul_f32 v[238:239], v[230:231], v[238:239]
v_exp_f32 v48, v48
v_exp_f32 v49, v49
v_exp_f32 v50, v50
v_exp_f32 v51, v51
v_exp_f32 v52, v52
v_exp_f32 v53, v53
v_exp_f32 v54, v54
v_exp_f32 v55, v55
v_pk_fma_f32 v[48:49], v[48:49], v[10:11], v[10:11] op_sel_hi:[1,0,0]
v_pk_fma_f32 v[50:51], v[50:51], v[10:11], v[10:11] op_sel_hi:[1,0,0]
v_pk_fma_f32 v[52:53], v[52:53], v[10:11], v[10:11] op_sel_hi:[1,0,0]
v_pk_fma_f32 v[54:55], v[54:55], v[10:11], v[10:11] op_sel_hi:[1,0,0]
v_rcp_f32 v48, v48
v_rcp_f32 v49, v49
v_rcp_f32 v50, v50
v_rcp_f32 v51, v51
v_rcp_f32 v52, v52
v_rcp_f32 v53, v53
v_rcp_f32 v54, v54
v_rcp_f32 v55, v55
v_pk_mul_f32 v[48:49], v[48:49], v[232:233]
v_pk_mul_f32 v[50:51], v[50:51], v[234:235]
v_pk_mul_f32 v[52:53], v[52:53], v[236:237]
v_pk_mul_f32 v[54:55], v[54:55], v[238:239]
v_cvt_pk_bf16_f32 v64, v48, v49
v_cvt_pk_bf16_f32 v65, v50, v51
v_cvt_pk_bf16_f32 v66, v52, v53
v_cvt_pk_bf16_f32 v67, v54, v55
global_store_dwordx4 v13, v[64:67], s[60:61] offset:0 sc1
v_pk_fma_f32 v[240:241], v[16:17], v[2:3], v[240:241] op_sel:[0,1,0] neg_lo:[0,1,0] neg_hi:[0,1,0]
v_pk_fma_f32 v[242:243], v[18:19], v[2:3], v[242:243] op_sel:[0,1,0] neg_lo:[0,1,0] neg_hi:[0,1,0]
v_pk_fma_f32 v[244:245], v[20:21], v[2:3], v[244:245] op_sel:[0,1,0] neg_lo:[0,1,0] neg_hi:[0,1,0]
v_pk_fma_f32 v[246:247], v[22:23], v[2:3], v[246:247] op_sel:[0,1,0] neg_lo:[0,1,0] neg_hi:[0,1,0]
v_pk_fma_f32 v[248:249], v[24:25], v[2:3], v[248:249] op_sel:[0,1,0] neg_lo:[0,1,0] neg_hi:[0,1,0]
v_pk_fma_f32 v[250:251], v[26:27], v[2:3], v[250:251] op_sel:[0,1,0] neg_lo:[0,1,0] neg_hi:[0,1,0]
v_pk_fma_f32 v[252:253], v[28:29], v[2:3], v[252:253] op_sel:[0,1,0] neg_lo:[0,1,0] neg_hi:[0,1,0]
v_pk_fma_f32 v[254:255], v[30:31], v[2:3], v[254:255] op_sel:[0,1,0] neg_lo:[0,1,0] neg_hi:[0,1,0]
v_pk_mul_f32 v[48:49], v[240:241], v[6:7] op_sel:[0,1]
v_pk_mul_f32 v[50:51], v[242:243], v[6:7] op_sel:[0,1]
v_pk_mul_f32 v[52:53], v[244:245], v[6:7] op_sel:[0,1]
v_pk_mul_f32 v[54:55], v[246:247], v[6:7] op_sel:[0,1]
v_pk_mul_f32 v[248:249], v[240:241], v[248:249]
v_pk_mul_f32 v[250:251], v[242:243], v[250:251]
v_pk_mul_f32 v[252:253], v[244:245], v[252:253]
v_pk_mul_f32 v[254:255], v[246:247], v[254:255]
v_exp_f32 v48, v48
v_exp_f32 v49, v49
v_exp_f32 v50, v50
v_exp_f32 v51, v51
v_exp_f32 v52, v52
v_exp_f32 v53, v53
v_exp_f32 v54, v54
v_exp_f32 v55, v55
v_pk_fma_f32 v[48:49], v[48:49], v[10:11], v[10:11] op_sel:[0,1,1]
v_pk_fma_f32 v[50:51], v[50:51], v[10:11], v[10:11] op_sel:[0,1,1]
v_pk_fma_f32 v[52:53], v[52:53], v[10:11], v[10:11] op_sel:[0,1,1]
v_pk_fma_f32 v[54:55], v[54:55], v[10:11], v[10:11] op_sel:[0,1,1]
v_rcp_f32 v48, v48
v_rcp_f32 v49, v49
v_rcp_f32 v50, v50
v_rcp_f32 v51, v51
v_rcp_f32 v52, v52
v_rcp_f32 v53, v53
v_rcp_f32 v54, v54
v_rcp_f32 v55, v55
v_pk_mul_f32 v[48:49], v[48:49], v[248:249]
v_pk_mul_f32 v[50:51], v[50:51], v[250:251]
v_pk_mul_f32 v[52:53], v[52:53], v[252:253]
v_pk_mul_f32 v[54:55], v[54:55], v[254:255]
v_cvt_pk_bf16_f32 v68, v48, v49
v_cvt_pk_bf16_f32 v69, v50, v51
v_cvt_pk_bf16_f32 v70, v52, v53
v_cvt_pk_bf16_f32 v71, v54, v55
global_store_dwordx4 v13, v[68:71], s[62:63] offset:0 sc1
L_ep_flag:
s_lshl_b32 s44, s39, 16
s_lshl_b32 s45, s36, 7
s_add_u32 s44, s44, s45
s_lshl_b32 s45, s24, 4
s_add_u32 s53, s44, s45
v_and_b32 v9, 31, v0
v_lshlrev_b32 v9, 10, v9
v_lshrrev_b32 v10, 5, v0
v_lshl_add_u32 v9, v10, 3, v9
v_add_u32 v9, s53, v9
global_load_dwordx2 v[188:189], v9, s[4:5]
v_add_u32 v9, 32768, v9
global_load_dwordx2 v[190:191], v9, s[4:5]
s_lshl_b32 s44, s39, 1
s_mul_i32 s45, s44, 112
s_mul_i32 s46, s24, 14
s_add_u32 s45, s45, s46
s_lshl_b32 s45, s45, 10
s_add_u32 s62, s22, s45
s_addc_u32 s63, s23, 0
s_lshl_b32 s45, s44, 5
s_lshl_b32 s46, s24, 2
s_add_u32 s45, s45, s46
s_lshl_b32 s45, s45, 10
s_add_u32 s45, s45, 7340032
s_add_u32 s68, s22, s45
s_addc_u32 s69, s23, 0
s_mov_b32 s61, 0xf
s_cmp_eq_u32 s24, 1
s_cselect_b32 s61, 0x70c, s61
s_cmp_eq_u32 s24, 2
s_cselect_b32 s61, 0x70b00, s61
s_cmp_eq_u32 s24, 3
s_cselect_b32 s61, 0x30c0c00, s61
v_lshlrev_b32 v6, 4, v0
v_lshrrev_b32 v9, 3, v0
v_lshlrev_b32 v9, 10, v9
v_bfe_u32 v10, v0, 4, 1
v_lshlrev_b32 v10, 2, v10
v_and_b32 v1, 7, v0
v_xor_b32 v1, v1, v10
v_lshl_add_u32 v1, v1, 4, v9
s_mul_i32 s56, s24, 229376
s_lshl_b32 s44, s36, 7
s_add_u32 s56, s56, s44
s_lshl_b32 s57, s24, 16
s_add_u32 s57, s57, s44
s_mul_i32 s60, s24, 12288
v_lshrrev_b32 v9, 5, v0
v_lshlrev_b32 v9, 3, v9
v_bfe_u32 v10, v0, 2, 2
v_add_u32 v9, v9, v10
v_lshlrev_b32 v9, 7, v9
v_bfe_u32 v10, v0, 3, 1
v_lshlrev_b32 v10, 2, v10
v_bfe_u32 v11, v0, 4, 1
v_lshl_add_u32 v10, v11, 1, v10
v_bfe_u32 v11, v0, 1, 1
v_add_u32 v10, v10, v11
v_lshl_add_u32 v9, v10, 4, v9
v_and_b32 v10, 1, v0
v_lshl_add_u32 v9, v10, 3, v9
v_add_u32 v2, s60, v9
v_xor_b32 v3, 64, v2
s_add_u32 s52, s60, 106496
v_lshrrev_b32 v9, 5, v0
v_lshlrev_b32 v9, 3, v9
v_bfe_u32 v10, v0, 2, 2
v_add_u32 v9, v9, v10
v_lshlrev_b32 v9, 7, v9
v_bfe_u32 v10, v0, 3, 1
v_lshlrev_b32 v10, 2, v10
v_bfe_u32 v11, v0, 4, 1
v_lshl_add_u32 v10, v11, 1, v10
v_bfe_u32 v11, v0, 1, 1
v_add_u32 v10, v10, v11
v_lshl_add_u32 v9, v10, 4, v9
v_and_b32 v10, 1, v0
v_lshl_add_u32 v9, v10, 3, v9
v_add_u32 v4, s52, v9
v_xor_b32 v5, 64, v4
s_add_u32 s52, s60, 53248
v_mov_b32 v7, v6
v_add_u32 v8, 114688, v6
v_mov_b32 v192, 0
v_mov_b32 v193, 0
v_mov_b32 v194, 0
v_mov_b32 v195, 0
v_mov_b32 v196, 0
v_mov_b32 v197, 0
v_mov_b32 v198, 0
v_mov_b32 v199, 0
v_mov_b32 v200, 0
v_mov_b32 v201, 0
v_mov_b32 v202, 0
v_mov_b32 v203, 0
v_mov_b32 v204, 0
v_mov_b32 v205, 0
v_mov_b32 v206, 0
v_mov_b32 v207, 0
v_mov_b32 v208, 0
v_mov_b32 v209, 0
v_mov_b32 v210, 0
v_mov_b32 v211, 0
v_mov_b32 v212, 0
v_mov_b32 v213, 0
v_mov_b32 v214, 0
v_mov_b32 v215, 0
v_mov_b32 v216, 0
v_mov_b32 v217, 0
v_mov_b32 v218, 0
v_mov_b32 v219, 0
v_mov_b32 v220, 0
v_mov_b32 v221, 0
v_mov_b32 v222, 0
v_mov_b32 v223, 0
v_mov_b32 v224, 0
v_mov_b32 v225, 0
v_mov_b32 v226, 0
v_mov_b32 v227, 0
v_mov_b32 v228, 0
v_mov_b32 v229, 0
v_mov_b32 v230, 0
v_mov_b32 v231, 0
v_mov_b32 v232, 0
v_mov_b32 v233, 0
v_mov_b32 v234, 0
v_mov_b32 v235, 0
v_mov_b32 v236, 0
v_mov_b32 v237, 0
v_mov_b32 v238, 0
v_mov_b32 v239, 0
v_mov_b32 v240, 0
v_mov_b32 v241, 0
v_mov_b32 v242, 0
v_mov_b32 v243, 0
v_mov_b32 v244, 0
v_mov_b32 v245, 0
v_mov_b32 v246, 0
v_mov_b32 v247, 0
v_mov_b32 v248, 0
v_mov_b32 v249, 0
v_mov_b32 v250, 0
v_mov_b32 v251, 0
v_mov_b32 v252, 0
v_mov_b32 v253, 0
v_mov_b32 v254, 0
v_mov_b32 v255, 0
s_lshl_b32 s44, s37, 2
s_and_b32 s45, s39, 3
s_add_u32 s44, s44, s45
s_lshl_b32 s44, s44, 7
s_add_u32 s44, s44, 9474048
v_and_b32 v9, 31, v0
v_lshlrev_b32 v9, 2, v9
v_add_u32 v9, s44, v9
s_waitcnt vmcnt(0)
s_lshl_b32 s44, s25, 2
s_add_u32 s44, s44, s38
s_lshl_b32 s44, s44, 5
s_add_u32 s44, s44, s76
s_lshl_b32 s44, s44, 2
s_add_u32 s44, s44, 9474048
v_mov_b32 v48, s44
v_mov_b32 v49, 1
s_mov_b64 s[64:65], exec
s_mov_b64 exec, 1
global_store_dword v48, v49, s[22:23] sc1
s_mov_b64 exec, s[64:65]
s_branch L_ep_done
L_ep_b1:
s_waitcnt lgkmcnt(0)
ds_read_b128 v[16:19], v12 offset:256
ds_read_b128 v[20:23], v12 offset:272
ds_read_b128 v[24:27], v12 offset:576
ds_read_b128 v[28:31], v12 offset:592
s_add_u32 s52, s27, 104
s_add_u32 s45, s51, 0
s_mul_i32 s45, s45, 112
s_add_u32 s45, s45, s52
s_lshl_b32 s45, s45, 10
s_add_u32 s60, s22, s45
s_addc_u32 s61, s23, 0
s_add_u32 s45, s51, 1
s_mul_i32 s45, s45, 112
s_add_u32 s45, s45, s52
s_lshl_b32 s45, s45, 10
s_add_u32 s62, s22, s45
s_addc_u32 s63, s23, 0
v_and_b32 v88, 31, v0
v_bfe_u32 v48, v0, 1, 2
v_lshrrev_b32 v49, 5, v0
v_xor_b32 v48, v48, v49
v_lshlrev_b32 v48, 4, v48
v_lshl_add_u32 v88, v88, 6, v48
s_lshl_b32 s45, s38, 13
s_add_u32 s45, s45, 53248
v_add_u32 v88, s45, v88
v_bfe_u32 v48, v0, 4, 1
v_lshlrev_b32 v48, 1, v48
v_and_b32 v49, 1, v0
v_add_u32 v48, v48, v49
v_bfe_u32 v49, v0, 3, 1
v_xor_b32 v48, v48, v49
v_lshlrev_b32 v48, 4, v48
v_bfe_u32 v49, v0, 1, 1
v_lshl_add_u32 v48, v49, 3, v48
v_lshrrev_b32 v49, 5, v0
v_lshlrev_b32 v49, 3, v49
v_bfe_u32 v50, v0, 2, 2
v_add_u32 v49, v49, v50
v_lshl_add_u32 v48, v49, 6, v48
v_add_u32 v89, s45, v48
v_xor_b32 v90, 32, v89
v_mov_b32 v91, 0x3f803f80
v_and_b32 v48, 16, v0
v_cmp_eq_u32 s[70:71], 0, v48
s_waitcnt lgkmcnt(0)
ds_read_b128 v[32:35], v12 offset:0
ds_read_b128 v[36:39], v12 offset:16
ds_read_b128 v[40:43], v12 offset:320
ds_read_b128 v[44:47], v12 offset:336
v_pk_fma_f32 v[224:225], v[16:17], v[2:3], v[224:225] op_sel_hi:[1,0,1] neg_lo:[0,1,0] neg_hi:[0,1,0]
v_pk_fma_f32 v[226:227], v[18:19], v[2:3], v[226:227] op_sel_hi:[1,0,1] neg_lo:[0,1,0] neg_hi:[0,1,0]
v_pk_fma_f32 v[228:229], v[20:21], v[2:3], v[228:229] op_sel_hi:[1,0,1] neg_lo:[0,1,0] neg_hi:[0,1,0]
v_pk_fma_f32 v[230:231], v[22:23], v[2:3], v[230:231] op_sel_hi:[1,0,1] neg_lo:[0,1,0] neg_hi:[0,1,0]
v_pk_fma_f32 v[232:233], v[24:25], v[2:3], v[232:233] op_sel_hi:[1,0,1] neg_lo:[0,1,0] neg_hi:[0,1,0]
v_pk_fma_f32 v[234:235], v[26:27], v[2:3], v[234:235] op_sel_hi:[1,0,1] neg_lo:[0,1,0] neg_hi:[0,1,0]
v_pk_fma_f32 v[236:237], v[28:29], v[2:3], v[236:237] op_sel_hi:[1,0,1] neg_lo:[0,1,0] neg_hi:[0,1,0]
v_pk_fma_f32 v[238:239], v[30:31], v[2:3], v[238:239] op_sel_hi:[1,0,1] neg_lo:[0,1,0] neg_hi:[0,1,0]
v_pk_mul_f32 v[48:49], v[224:225], v[6:7] op_sel_hi:[1,0]
v_pk_mul_f32 v[50:51], v[226:227], v[6:7] op_sel_hi:[1,0]
v_pk_mul_f32 v[52:53], v[228:229], v[6:7] op_sel_hi:[1,0]
v_pk_mul_f32 v[54:55], v[230:231], v[6:7] op_sel_hi:[1,0]
v_pk_mul_f32 v[232:233], v[224:225], v[232:233]
v_pk_mul_f32 v[234:235], v[226:227], v[234:235]
v_pk_mul_f32 v[236:237], v[228:229], v[236:237]
v_pk_mul_f32 v[238:239], v[230:231], v[238:239]
v_exp_f32 v48, v48
v_exp_f32 v49, v49
v_exp_f32 v50, v50
v_exp_f32 v51, v51
v_exp_f32 v52, v52
v_exp_f32 v53, v53
v_exp_f32 v54, v54
v_exp_f32 v55, v55
v_pk_fma_f32 v[48:49], v[48:49], v[10:11], v[10:11] op_sel_hi:[1,0,0]
v_pk_fma_f32 v[50:51], v[50:51], v[10:11], v[10:11] op_sel_hi:[1,0,0]
v_pk_fma_f32 v[52:53], v[52:53], v[10:11], v[10:11] op_sel_hi:[1,0,0]
v_pk_fma_f32 v[54:55], v[54:55], v[10:11], v[10:11] op_sel_hi:[1,0,0]
v_rcp_f32 v48, v48
v_rcp_f32 v49, v49
v_rcp_f32 v50, v50
v_rcp_f32 v51, v51
v_rcp_f32 v52, v52
v_rcp_f32 v53, v53
v_rcp_f32 v54, v54
v_rcp_f32 v55, v55
v_pk_mul_f32 v[48:49], v[48:49], v[232:233]
v_pk_mul_f32 v[50:51], v[50:51], v[234:235]
v_pk_mul_f32 v[52:53], v[52:53], v[236:237]
v_pk_mul_f32 v[54:55], v[54:55], v[238:239]
v_cvt_pk_bf16_f32 v64, v48, v49
v_cvt_pk_bf16_f32 v65, v50, v51
v_cvt_pk_bf16_f32 v66, v52, v53
v_cvt_pk_bf16_f32 v67, v54, v55
global_store_dwordx4 v13, v[64:67], s[60:61] offset:0 sc1
v_pk_fma_f32 v[240:241], v[16:17], v[2:3], v[240:241] op_sel:[0,1,0] neg_lo:[0,1,0] neg_hi:[0,1,0]
v_pk_fma_f32 v[242:243], v[18:19], v[2:3], v[242:243] op_sel:[0,1,0] neg_lo:[0,1,0] neg_hi:[0,1,0]
v_pk_fma_f32 v[244:245], v[20:21], v[2:3], v[244:245] op_sel:[0,1,0] neg_lo:[0,1,0] neg_hi:[0,1,0]
v_pk_fma_f32 v[246:247], v[22:23], v[2:3], v[246:247] op_sel:[0,1,0] neg_lo:[0,1,0] neg_hi:[0,1,0]
v_pk_fma_f32 v[248:249], v[24:25], v[2:3], v[248:249] op_sel:[0,1,0] neg_lo:[0,1,0] neg_hi:[0,1,0]
v_pk_fma_f32 v[250:251], v[26:27], v[2:3], v[250:251] op_sel:[0,1,0] neg_lo:[0,1,0] neg_hi:[0,1,0]
v_pk_fma_f32 v[252:253], v[28:29], v[2:3], v[252:253] op_sel:[0,1,0] neg_lo:[0,1,0] neg_hi:[0,1,0]
v_pk_fma_f32 v[254:255], v[30:31], v[2:3], v[254:255] op_sel:[0,1,0] neg_lo:[0,1,0] neg_hi:[0,1,0]
v_pk_mul_f32 v[48:49], v[240:241], v[6:7] op_sel:[0,1]
v_pk_mul_f32 v[50:51], v[242:243], v[6:7] op_sel:[0,1]
v_pk_mul_f32 v[52:53], v[244:245], v[6:7] op_sel:[0,1]
v_pk_mul_f32 v[54:55], v[246:247], v[6:7] op_sel:[0,1]
v_pk_mul_f32 v[248:249], v[240:241], v[248:249]
v_pk_mul_f32 v[250:251], v[242:243], v[250:251]
v_pk_mul_f32 v[252:253], v[244:245], v[252:253]
v_pk_mul_f32 v[254:255], v[246:247], v[254:255]
v_exp_f32 v48, v48
v_exp_f32 v49, v49
v_exp_f32 v50, v50
v_exp_f32 v51, v51
v_exp_f32 v52, v52
v_exp_f32 v53, v53
v_exp_f32 v54, v54
v_exp_f32 v55, v55
v_pk_fma_f32 v[48:49], v[48:49], v[10:11], v[10:11] op_sel:[0,1,1]
v_pk_fma_f32 v[50:51], v[50:51], v[10:11], v[10:11] op_sel:[0,1,1]
v_pk_fma_f32 v[52:53], v[52:53], v[10:11], v[10:11] op_sel:[0,1,1]
v_pk_fma_f32 v[54:55], v[54:55], v[10:11], v[10:11] op_sel:[0,1,1]
v_rcp_f32 v48, v48
v_rcp_f32 v49, v49
v_rcp_f32 v50, v50
v_rcp_f32 v51, v51
v_rcp_f32 v52, v52
v_rcp_f32 v53, v53
v_rcp_f32 v54, v54
v_rcp_f32 v55, v55
v_pk_mul_f32 v[48:49], v[48:49], v[248:249]
v_pk_mul_f32 v[50:51], v[50:51], v[250:251]
v_pk_mul_f32 v[52:53], v[52:53], v[252:253]
v_pk_mul_f32 v[54:55], v[54:55], v[254:255]
v_cvt_pk_bf16_f32 v68, v48, v49
v_cvt_pk_bf16_f32 v69, v50, v51
v_cvt_pk_bf16_f32 v70, v52, v53
v_cvt_pk_bf16_f32 v71, v54, v55
global_store_dwordx4 v13, v[68:71], s[62:63] offset:0 sc1
s_waitcnt lgkmcnt(0)
ds_read_b128 v[16:19], v12 offset:64
ds_read_b128 v[20:23], v12 offset:80
ds_read_b128 v[24:27], v12 offset:384
ds_read_b128 v[28:31], v12 offset:400
v_pk_fma_f32 v[96:97], v[32:33], v[2:3], v[96:97] op_sel_hi:[1,0,1] neg_lo:[0,1,0] neg_hi:[0,1,0]
v_pk_fma_f32 v[98:99], v[34:35], v[2:3], v[98:99] op_sel_hi:[1,0,1] neg_lo:[0,1,0] neg_hi:[0,1,0]
v_pk_fma_f32 v[100:101], v[36:37], v[2:3], v[100:101] op_sel_hi:[1,0,1] neg_lo:[0,1,0] neg_hi:[0,1,0]
v_pk_fma_f32 v[102:103], v[38:39], v[2:3], v[102:103] op_sel_hi:[1,0,1] neg_lo:[0,1,0] neg_hi:[0,1,0]
v_pk_fma_f32 v[104:105], v[40:41], v[2:3], v[104:105] op_sel_hi:[1,0,1] neg_lo:[0,1,0] neg_hi:[0,1,0]
v_pk_fma_f32 v[106:107], v[42:43], v[2:3], v[106:107] op_sel_hi:[1,0,1] neg_lo:[0,1,0] neg_hi:[0,1,0]
v_pk_fma_f32 v[108:109], v[44:45], v[2:3], v[108:109] op_sel_hi:[1,0,1] neg_lo:[0,1,0] neg_hi:[0,1,0]
v_pk_fma_f32 v[110:111], v[46:47], v[2:3], v[110:111] op_sel_hi:[1,0,1] neg_lo:[0,1,0] neg_hi:[0,1,0]
v_pk_mul_f32 v[96:97], v[96:97], v[8:9] op_sel_hi:[1,0]
v_pk_mul_f32 v[98:99], v[98:99], v[8:9] op_sel_hi:[1,0]
v_pk_mul_f32 v[100:101], v[100:101], v[8:9] op_sel_hi:[1,0]
v_pk_mul_f32 v[102:103], v[102:103], v[8:9] op_sel_hi:[1,0]
v_min_f32 v48, 0, v96
v_min_f32 v49, 0, v97
v_min_f32 v50, 0, v98
v_min_f32 v51, 0, v99
v_min_f32 v52, 0, v100
v_min_f32 v53, 0, v101
v_min_f32 v54, 0, v102
v_min_f32 v55, 0, v103
v_pk_add_f32 v[96:97], v[96:97], v[48:49] neg_lo:[0,1] neg_hi:[0,1]
v_pk_add_f32 v[98:99], v[98:99], v[50:51] neg_lo:[0,1] neg_hi:[0,1]
v_pk_add_f32 v[100:101], v[100:101], v[52:53] neg_lo:[0,1] neg_hi:[0,1]
v_pk_add_f32 v[102:103], v[102:103], v[54:55] neg_lo:[0,1] neg_hi:[0,1]
v_exp_f32 v48, v48
v_exp_f32 v49, v49
v_exp_f32 v50, v50
v_exp_f32 v51, v51
v_exp_f32 v52, v52
v_exp_f32 v53, v53
v_exp_f32 v54, v54
v_exp_f32 v55, v55
v_pk_fma_f32 v[96:97], v[96:97], v[14:15], v[14:15] op_sel:[0,0,1] op_sel_hi:[1,0,1]
v_pk_fma_f32 v[98:99], v[98:99], v[14:15], v[14:15] op_sel:[0,0,1] op_sel_hi:[1,0,1]
v_pk_fma_f32 v[100:101], v[100:101], v[14:15], v[14:15] op_sel:[0,0,1] op_sel_hi:[1,0,1]
v_pk_fma_f32 v[102:103], v[102:103], v[14:15], v[14:15] op_sel:[0,0,1] op_sel_hi:[1,0,1]
v_pk_add_f32 v[96:97], v[96:97], v[48:49]
v_pk_add_f32 v[98:99], v[98:99], v[50:51]
v_pk_add_f32 v[100:101], v[100:101], v[52:53]
v_pk_add_f32 v[102:103], v[102:103], v[54:55]
v_cvt_pk_bf16_f32 v64, v96, v97
v_cvt_pk_bf16_f32 v65, v98, v99
v_cvt_pk_bf16_f32 v66, v100, v101
v_cvt_pk_bf16_f32 v67, v102, v103
v_pk_mul_f32 v[104:105], v[104:105], v[4:5] op_sel_hi:[1,0]
v_pk_mul_f32 v[106:107], v[106:107], v[4:5] op_sel_hi:[1,0]
v_pk_mul_f32 v[108:109], v[108:109], v[4:5] op_sel_hi:[1,0]
v_pk_mul_f32 v[110:111], v[110:111], v[4:5] op_sel_hi:[1,0]
v_cvt_pk_bf16_f32 v68, v104, v105
v_cvt_pk_bf16_f32 v69, v106, v107
v_cvt_pk_bf16_f32 v70, v108, v109
v_cvt_pk_bf16_f32 v71, v110, v111
ds_write_b128 v88, v[64:67] offset:0
v_xor_b32 v56, 32, v88
ds_write_b128 v56, v[68:71] offset:0
v_pk_fma_f32 v[112:113], v[32:33], v[2:3], v[112:113] op_sel:[0,1,0] neg_lo:[0,1,0] neg_hi:[0,1,0]
v_pk_fma_f32 v[114:115], v[34:35], v[2:3], v[114:115] op_sel:[0,1,0] neg_lo:[0,1,0] neg_hi:[0,1,0]
v_pk_fma_f32 v[116:117], v[36:37], v[2:3], v[116:117] op_sel:[0,1,0] neg_lo:[0,1,0] neg_hi:[0,1,0]
v_pk_fma_f32 v[118:119], v[38:39], v[2:3], v[118:119] op_sel:[0,1,0] neg_lo:[0,1,0] neg_hi:[0,1,0]
v_pk_fma_f32 v[120:121], v[40:41], v[2:3], v[120:121] op_sel:[0,1,0] neg_lo:[0,1,0] neg_hi:[0,1,0]
v_pk_fma_f32 v[122:123], v[42:43], v[2:3], v[122:123] op_sel:[0,1,0] neg_lo:[0,1,0] neg_hi:[0,1,0]
v_pk_fma_f32 v[124:125], v[44:45], v[2:3], v[124:125] op_sel:[0,1,0] neg_lo:[0,1,0] neg_hi:[0,1,0]
v_pk_fma_f32 v[126:127], v[46:47], v[2:3], v[126:127] op_sel:[0,1,0] neg_lo:[0,1,0] neg_hi:[0,1,0]
v_pk_mul_f32 v[112:113], v[112:113], v[8:9] op_sel:[0,1]
v_pk_mul_f32 v[114:115], v[114:115], v[8:9] op_sel:[0,1]
v_pk_mul_f32 v[116:117], v[116:117], v[8:9] op_sel:[0,1]
v_pk_mul_f32 v[118:119], v[118:119], v[8:9] op_sel:[0,1]
v_min_f32 v48, 0, v112
v_min_f32 v49, 0, v113
v_min_f32 v50, 0, v114
v_min_f32 v51, 0, v115
v_min_f32 v52, 0, v116
v_min_f32 v53, 0, v117
v_min_f32 v54, 0, v118
v_min_f32 v55, 0, v119
v_pk_add_f32 v[112:113], v[112:113], v[48:49] neg_lo:[0,1] neg_hi:[0,1]
v_pk_add_f32 v[114:115], v[114:115], v[50:51] neg_lo:[0,1] neg_hi:[0,1]
v_pk_add_f32 v[116:117], v[116:117], v[52:53] neg_lo:[0,1] neg_hi:[0,1]
v_pk_add_f32 v[118:119], v[118:119], v[54:55] neg_lo:[0,1] neg_hi:[0,1]
v_exp_f32 v48, v48
v_exp_f32 v49, v49
v_exp_f32 v50, v50
v_exp_f32 v51, v51
v_exp_f32 v52, v52
v_exp_f32 v53, v53
v_exp_f32 v54, v54
v_exp_f32 v55, v55
v_pk_fma_f32 v[112:113], v[112:113], v[14:15], v[14:15] op_sel:[0,0,1] op_sel_hi:[1,0,1]
v_pk_fma_f32 v[114:115], v[114:115], v[14:15], v[14:15] op_sel:[0,0,1] op_sel_hi:[1,0,1]
v_pk_fma_f32 v[116:117], v[116:117], v[14:15], v[14:15] op_sel:[0,0,1] op_sel_hi:[1,0,1]
v_pk_fma_f32 v[118:119], v[118:119], v[14:15], v[14:15] op_sel:[0,0,1] op_sel_hi:[1,0,1]
v_pk_add_f32 v[112:113], v[112:113], v[48:49]
v_pk_add_f32 v[114:115], v[114:115], v[50:51]
v_pk_add_f32 v[116:117], v[116:117], v[52:53]
v_pk_add_f32 v[118:119], v[118:119], v[54:55]
v_cvt_pk_bf16_f32 v64, v112, v113
v_cvt_pk_bf16_f32 v65, v114, v115
v_cvt_pk_bf16_f32 v66, v116, v117
v_cvt_pk_bf16_f32 v67, v118, v119
v_pk_mul_f32 v[120:121], v[120:121], v[4:5] op_sel:[0,1]
v_pk_mul_f32 v[122:123], v[122:123], v[4:5] op_sel:[0,1]
v_pk_mul_f32 v[124:125], v[124:125], v[4:5] op_sel:[0,1]
v_pk_mul_f32 v[126:127], v[126:127], v[4:5] op_sel:[0,1]
v_cvt_pk_bf16_f32 v68, v120, v121
v_cvt_pk_bf16_f32 v69, v122, v123
v_cvt_pk_bf16_f32 v70, v124, v125
v_cvt_pk_bf16_f32 v71, v126, v127
ds_write_b128 v88, v[64:67] offset:2048
v_xor_b32 v56, 32, v88
ds_write_b128 v56, v[68:71] offset:2048
s_waitcnt vmcnt(0)
s_lshl_b32 s44, s25, 2
s_add_u32 s44, s44, s38
s_lshl_b32 s44, s44, 5
s_add_u32 s44, s44, s76
s_lshl_b32 s44, s44, 2
s_add_u32 s44, s44, 9474048
v_mov_b32 v48, s44
v_mov_b32 v49, 1
s_mov_b64 s[64:65], exec
s_mov_b64 exec, 1
global_store_dword v48, v49, s[22:23] sc1
s_mov_b64 exec, s[64:65]
s_waitcnt lgkmcnt(0)
ds_read_b128 v[32:35], v12 offset:128
ds_read_b128 v[36:39], v12 offset:144
ds_read_b128 v[40:43], v12 offset:448
ds_read_b128 v[44:47], v12 offset:464
v_pk_fma_f32 v[128:129], v[16:17], v[2:3], v[128:129] op_sel_hi:[1,0,1] neg_lo:[0,1,0] neg_hi:[0,1,0]
v_pk_fma_f32 v[130:131], v[18:19], v[2:3], v[130:131] op_sel_hi:[1,0,1] neg_lo:[0,1,0] neg_hi:[0,1,0]
v_pk_fma_f32 v[132:133], v[20:21], v[2:3], v[132:133] op_sel_hi:[1,0,1] neg_lo:[0,1,0] neg_hi:[0,1,0]
v_pk_fma_f32 v[134:135], v[22:23], v[2:3], v[134:135] op_sel_hi:[1,0,1] neg_lo:[0,1,0] neg_hi:[0,1,0]
v_pk_fma_f32 v[136:137], v[24:25], v[2:3], v[136:137] op_sel_hi:[1,0,1] neg_lo:[0,1,0] neg_hi:[0,1,0]
v_pk_fma_f32 v[138:139], v[26:27], v[2:3], v[138:139] op_sel_hi:[1,0,1] neg_lo:[0,1,0] neg_hi:[0,1,0]
v_pk_fma_f32 v[140:141], v[28:29], v[2:3], v[140:141] op_sel_hi:[1,0,1] neg_lo:[0,1,0] neg_hi:[0,1,0]
v_pk_fma_f32 v[142:143], v[30:31], v[2:3], v[142:143] op_sel_hi:[1,0,1] neg_lo:[0,1,0] neg_hi:[0,1,0]
v_pk_mul_f32 v[128:129], v[128:129], v[8:9] op_sel_hi:[1,0]
v_pk_mul_f32 v[130:131], v[130:131], v[8:9] op_sel_hi:[1,0]
v_pk_mul_f32 v[132:133], v[132:133], v[8:9] op_sel_hi:[1,0]
v_pk_mul_f32 v[134:135], v[134:135], v[8:9] op_sel_hi:[1,0]
v_min_f32 v48, 0, v128
v_min_f32 v49, 0, v129
v_min_f32 v50, 0, v130
v_min_f32 v51, 0, v131
v_min_f32 v52, 0, v132
v_min_f32 v53, 0, v133
v_min_f32 v54, 0, v134
v_min_f32 v55, 0, v135
v_pk_add_f32 v[128:129], v[128:129], v[48:49] neg_lo:[0,1] neg_hi:[0,1]
v_pk_add_f32 v[130:131], v[130:131], v[50:51] neg_lo:[0,1] neg_hi:[0,1]
v_pk_add_f32 v[132:133], v[132:133], v[52:53] neg_lo:[0,1] neg_hi:[0,1]
v_pk_add_f32 v[134:135], v[134:135], v[54:55] neg_lo:[0,1] neg_hi:[0,1]
v_exp_f32 v48, v48
v_exp_f32 v49, v49
v_exp_f32 v50, v50
v_exp_f32 v51, v51
v_exp_f32 v52, v52
v_exp_f32 v53, v53
v_exp_f32 v54, v54
v_exp_f32 v55, v55
v_pk_fma_f32 v[128:129], v[128:129], v[14:15], v[14:15] op_sel:[0,0,1] op_sel_hi:[1,0,1]
v_pk_fma_f32 v[130:131], v[130:131], v[14:15], v[14:15] op_sel:[0,0,1] op_sel_hi:[1,0,1]
v_pk_fma_f32 v[132:133], v[132:133], v[14:15], v[14:15] op_sel:[0,0,1] op_sel_hi:[1,0,1]
v_pk_fma_f32 v[134:135], v[134:135], v[14:15], v[14:15] op_sel:[0,0,1] op_sel_hi:[1,0,1]
v_pk_add_f32 v[128:129], v[128:129], v[48:49]
v_pk_add_f32 v[130:131], v[130:131], v[50:51]
v_pk_add_f32 v[132:133], v[132:133], v[52:53]
v_pk_add_f32 v[134:135], v[134:135], v[54:55]
v_cvt_pk_bf16_f32 v64, v128, v129
v_cvt_pk_bf16_f32 v65, v130, v131
v_cvt_pk_bf16_f32 v66, v132, v133
v_cvt_pk_bf16_f32 v67, v134, v135
v_pk_mul_f32 v[136:137], v[136:137], v[4:5] op_sel_hi:[1,0]
v_pk_mul_f32 v[138:139], v[138:139], v[4:5] op_sel_hi:[1,0]
v_pk_mul_f32 v[140:141], v[140:141], v[4:5] op_sel_hi:[1,0]
v_pk_mul_f32 v[142:143], v[142:143], v[4:5] op_sel_hi:[1,0]
v_cvt_pk_bf16_f32 v68, v136, v137
v_cvt_pk_bf16_f32 v69, v138, v139
v_cvt_pk_bf16_f32 v70, v140, v141
v_cvt_pk_bf16_f32 v71, v142, v143
ds_write_b128 v88, v[64:67] offset:4096
v_xor_b32 v56, 32, v88
ds_write_b128 v56, v[68:71] offset:4096
v_pk_fma_f32 v[144:145], v[16:17], v[2:3], v[144:145] op_sel:[0,1,0] neg_lo:[0,1,0] neg_hi:[0,1,0]
v_pk_fma_f32 v[146:147], v[18:19], v[2:3], v[146:147] op_sel:[0,1,0] neg_lo:[0,1,0] neg_hi:[0,1,0]
v_pk_fma_f32 v[148:149], v[20:21], v[2:3], v[148:149] op_sel:[0,1,0] neg_lo:[0,1,0] neg_hi:[0,1,0]
v_pk_fma_f32 v[150:151], v[22:23], v[2:3], v[150:151] op_sel:[0,1,0] neg_lo:[0,1,0] neg_hi:[0,1,0]
v_pk_fma_f32 v[152:153], v[24:25], v[2:3], v[152:153] op_sel:[0,1,0] neg_lo:[0,1,0] neg_hi:[0,1,0]
v_pk_fma_f32 v[154:155], v[26:27], v[2:3], v[154:155] op_sel:[0,1,0] neg_lo:[0,1,0] neg_hi:[0,1,0]
v_pk_fma_f32 v[156:157], v[28:29], v[2:3], v[156:157] op_sel:[0,1,0] neg_lo:[0,1,0] neg_hi:[0,1,0]
v_pk_fma_f32 v[158:159], v[30:31], v[2:3], v[158:159] op_sel:[0,1,0] neg_lo:[0,1,0] neg_hi:[0,1,0]
v_pk_mul_f32 v[144:145], v[144:145], v[8:9] op_sel:[0,1]
v_pk_mul_f32 v[146:147], v[146:147], v[8:9] op_sel:[0,1]
v_pk_mul_f32 v[148:149], v[148:149], v[8:9] op_sel:[0,1]
v_pk_mul_f32 v[150:151], v[150:151], v[8:9] op_sel:[0,1]
v_min_f32 v48, 0, v144
v_min_f32 v49, 0, v145
v_min_f32 v50, 0, v146
v_min_f32 v51, 0, v147
v_min_f32 v52, 0, v148
v_min_f32 v53, 0, v149
v_min_f32 v54, 0, v150
v_min_f32 v55, 0, v151
v_pk_add_f32 v[144:145], v[144:145], v[48:49] neg_lo:[0,1] neg_hi:[0,1]
v_pk_add_f32 v[146:147], v[146:147], v[50:51] neg_lo:[0,1] neg_hi:[0,1]
v_pk_add_f32 v[148:149], v[148:149], v[52:53] neg_lo:[0,1] neg_hi:[0,1]
v_pk_add_f32 v[150:151], v[150:151], v[54:55] neg_lo:[0,1] neg_hi:[0,1]
v_exp_f32 v48, v48
v_exp_f32 v49, v49
v_exp_f32 v50, v50
v_exp_f32 v51, v51
v_exp_f32 v52, v52
v_exp_f32 v53, v53
v_exp_f32 v54, v54
v_exp_f32 v55, v55
v_pk_fma_f32 v[144:145], v[144:145], v[14:15], v[14:15] op_sel:[0,0,1] op_sel_hi:[1,0,1]
v_pk_fma_f32 v[146:147], v[146:147], v[14:15], v[14:15] op_sel:[0,0,1] op_sel_hi:[1,0,1]
v_pk_fma_f32 v[148:149], v[148:149], v[14:15], v[14:15] op_sel:[0,0,1] op_sel_hi:[1,0,1]
v_pk_fma_f32 v[150:151], v[150:151], v[14:15], v[14:15] op_sel:[0,0,1] op_sel_hi:[1,0,1]
v_pk_add_f32 v[144:145], v[144:145], v[48:49]
v_pk_add_f32 v[146:147], v[146:147], v[50:51]
v_pk_add_f32 v[148:149], v[148:149], v[52:53]
v_pk_add_f32 v[150:151], v[150:151], v[54:55]
v_cvt_pk_bf16_f32 v64, v144, v145
v_cvt_pk_bf16_f32 v65, v146, v147
v_cvt_pk_bf16_f32 v66, v148, v149
v_cvt_pk_bf16_f32 v67, v150, v151
v_pk_mul_f32 v[152:153], v[152:153], v[4:5] op_sel:[0,1]
v_pk_mul_f32 v[154:155], v[154:155], v[4:5] op_sel:[0,1]
v_pk_mul_f32 v[156:157], v[156:157], v[4:5] op_sel:[0,1]
v_pk_mul_f32 v[158:159], v[158:159], v[4:5] op_sel:[0,1]
v_cvt_pk_bf16_f32 v68, v152, v153
v_cvt_pk_bf16_f32 v69, v154, v155
v_cvt_pk_bf16_f32 v70, v156, v157
v_cvt_pk_bf16_f32 v71, v158, v159
ds_write_b128 v88, v[64:67] offset:6144
v_xor_b32 v56, 32, v88
ds_write_b128 v56, v[68:71] offset:6144
s_waitcnt lgkmcnt(0)
ds_read_b64_tr_b16 v[72:73], v89 offset:0
ds_read_b64_tr_b16 v[74:75], v90 offset:256
ds_read_b64_tr_b16 v[76:77], v89 offset:1024
ds_read_b64_tr_b16 v[78:79], v90 offset:1280
ds_read_b64_tr_b16 v[80:81], v89 offset:2048
ds_read_b64_tr_b16 v[82:83], v90 offset:2304
ds_read_b64_tr_b16 v[84:85], v89 offset:3072
ds_read_b64_tr_b16 v[86:87], v90 offset:3328
ds_read_b128 v[16:19], v12 offset:192
ds_read_b128 v[20:23], v12 offset:208
ds_read_b128 v[24:27], v12 offset:512
ds_read_b128 v[28:31], v12 offset:528
s_waitcnt lgkmcnt(0)
v_cndmask_b32 v56, v72, v91, s[70:71]
v_cndmask_b32 v57, v73, v91, s[70:71]
v_cndmask_b32 v58, v74, v91, s[70:71]
v_cndmask_b32 v59, v75, v91, s[70:71]
s_nop 1
v_mfma_f32_32x32x16_bf16 v[96:111], v[72:75], v[56:59], 0
v_cndmask_b32 v92, v76, v91, s[70:71]
v_cndmask_b32 v93, v77, v91, s[70:71]
v_cndmask_b32 v94, v78, v91, s[70:71]
v_cndmask_b32 v95, v79, v91, s[70:71]
s_nop 1
v_mfma_f32_32x32x16_bf16 v[96:111], v[76:79], v[92:95], v[96:111]
v_cndmask_b32 v56, v80, v91, s[70:71]
v_cndmask_b32 v57, v81, v91, s[70:71]
v_cndmask_b32 v58, v82, v91, s[70:71]
v_cndmask_b32 v59, v83, v91, s[70:71]
s_nop 1
v_mfma_f32_32x32x16_bf16 v[96:111], v[80:83], v[56:59], v[96:111]
v_cndmask_b32 v92, v84, v91, s[70:71]
v_cndmask_b32 v93, v85, v91, s[70:71]
v_cndmask_b32 v94, v86, v91, s[70:71]
v_cndmask_b32 v95, v87, v91, s[70:71]
s_nop 1
v_mfma_f32_32x32x16_bf16 v[96:111], v[84:87], v[92:95], v[96:111]
v_pk_fma_f32 v[160:161], v[32:33], v[2:3], v[160:161] op_sel_hi:[1,0,1] neg_lo:[0,1,0] neg_hi:[0,1,0]
v_pk_fma_f32 v[162:163], v[34:35], v[2:3], v[162:163] op_sel_hi:[1,0,1] neg_lo:[0,1,0] neg_hi:[0,1,0]
v_pk_fma_f32 v[164:165], v[36:37], v[2:3], v[164:165] op_sel_hi:[1,0,1] neg_lo:[0,1,0] neg_hi:[0,1,0]
v_pk_fma_f32 v[166:167], v[38:39], v[2:3], v[166:167] op_sel_hi:[1,0,1] neg_lo:[0,1,0] neg_hi:[0,1,0]
v_pk_fma_f32 v[168:169], v[40:41], v[2:3], v[168:169] op_sel_hi:[1,0,1] neg_lo:[0,1,0] neg_hi:[0,1,0]
v_pk_fma_f32 v[170:171], v[42:43], v[2:3], v[170:171] op_sel_hi:[1,0,1] neg_lo:[0,1,0] neg_hi:[0,1,0]
v_pk_fma_f32 v[172:173], v[44:45], v[2:3], v[172:173] op_sel_hi:[1,0,1] neg_lo:[0,1,0] neg_hi:[0,1,0]
v_pk_fma_f32 v[174:175], v[46:47], v[2:3], v[174:175] op_sel_hi:[1,0,1] neg_lo:[0,1,0] neg_hi:[0,1,0]
v_pk_mul_f32 v[160:161], v[160:161], v[8:9] op_sel_hi:[1,0]
v_pk_mul_f32 v[162:163], v[162:163], v[8:9] op_sel_hi:[1,0]
v_pk_mul_f32 v[164:165], v[164:165], v[8:9] op_sel_hi:[1,0]
v_pk_mul_f32 v[166:167], v[166:167], v[8:9] op_sel_hi:[1,0]
v_min_f32 v48, 0, v160
v_min_f32 v49, 0, v161
v_min_f32 v50, 0, v162
v_min_f32 v51, 0, v163
v_min_f32 v52, 0, v164
v_min_f32 v53, 0, v165
v_min_f32 v54, 0, v166
v_min_f32 v55, 0, v167
v_pk_add_f32 v[160:161], v[160:161], v[48:49] neg_lo:[0,1] neg_hi:[0,1]
v_pk_add_f32 v[162:163], v[162:163], v[50:51] neg_lo:[0,1] neg_hi:[0,1]
v_pk_add_f32 v[164:165], v[164:165], v[52:53] neg_lo:[0,1] neg_hi:[0,1]
v_pk_add_f32 v[166:167], v[166:167], v[54:55] neg_lo:[0,1] neg_hi:[0,1]
v_exp_f32 v48, v48
v_exp_f32 v49, v49
v_exp_f32 v50, v50
v_exp_f32 v51, v51
v_exp_f32 v52, v52
v_exp_f32 v53, v53
v_exp_f32 v54, v54
v_exp_f32 v55, v55
v_pk_fma_f32 v[160:161], v[160:161], v[14:15], v[14:15] op_sel:[0,0,1] op_sel_hi:[1,0,1]
v_pk_fma_f32 v[162:163], v[162:163], v[14:15], v[14:15] op_sel:[0,0,1] op_sel_hi:[1,0,1]
v_pk_fma_f32 v[164:165], v[164:165], v[14:15], v[14:15] op_sel:[0,0,1] op_sel_hi:[1,0,1]
v_pk_fma_f32 v[166:167], v[166:167], v[14:15], v[14:15] op_sel:[0,0,1] op_sel_hi:[1,0,1]
v_pk_add_f32 v[160:161], v[160:161], v[48:49]
v_pk_add_f32 v[162:163], v[162:163], v[50:51]
v_pk_add_f32 v[164:165], v[164:165], v[52:53]
v_pk_add_f32 v[166:167], v[166:167], v[54:55]
v_cvt_pk_bf16_f32 v64, v160, v161
v_cvt_pk_bf16_f32 v65, v162, v163
v_cvt_pk_bf16_f32 v66, v164, v165
v_cvt_pk_bf16_f32 v67, v166, v167
v_pk_mul_f32 v[168:169], v[168:169], v[4:5] op_sel_hi:[1,0]
v_pk_mul_f32 v[170:171], v[170:171], v[4:5] op_sel_hi:[1,0]
v_pk_mul_f32 v[172:173], v[172:173], v[4:5] op_sel_hi:[1,0]
v_pk_mul_f32 v[174:175], v[174:175], v[4:5] op_sel_hi:[1,0]
v_cvt_pk_bf16_f32 v68, v168, v169
v_cvt_pk_bf16_f32 v69, v170, v171
v_cvt_pk_bf16_f32 v70, v172, v173
v_cvt_pk_bf16_f32 v71, v174, v175
ds_write_b128 v88, v[64:67] offset:0
v_xor_b32 v56, 32, v88
ds_write_b128 v56, v[68:71] offset:0
v_pk_fma_f32 v[176:177], v[32:33], v[2:3], v[176:177] op_sel:[0,1,0] neg_lo:[0,1,0] neg_hi:[0,1,0]
v_pk_fma_f32 v[178:179], v[34:35], v[2:3], v[178:179] op_sel:[0,1,0] neg_lo:[0,1,0] neg_hi:[0,1,0]
v_pk_fma_f32 v[180:181], v[36:37], v[2:3], v[180:181] op_sel:[0,1,0] neg_lo:[0,1,0] neg_hi:[0,1,0]
v_pk_fma_f32 v[182:183], v[38:39], v[2:3], v[182:183] op_sel:[0,1,0] neg_lo:[0,1,0] neg_hi:[0,1,0]
v_pk_fma_f32 v[184:185], v[40:41], v[2:3], v[184:185] op_sel:[0,1,0] neg_lo:[0,1,0] neg_hi:[0,1,0]
v_pk_fma_f32 v[186:187], v[42:43], v[2:3], v[186:187] op_sel:[0,1,0] neg_lo:[0,1,0] neg_hi:[0,1,0]
v_pk_fma_f32 v[188:189], v[44:45], v[2:3], v[188:189] op_sel:[0,1,0] neg_lo:[0,1,0] neg_hi:[0,1,0]
v_pk_fma_f32 v[190:191], v[46:47], v[2:3], v[190:191] op_sel:[0,1,0] neg_lo:[0,1,0] neg_hi:[0,1,0]
v_pk_mul_f32 v[176:177], v[176:177], v[8:9] op_sel:[0,1]
v_pk_mul_f32 v[178:179], v[178:179], v[8:9] op_sel:[0,1]
v_pk_mul_f32 v[180:181], v[180:181], v[8:9] op_sel:[0,1]
v_pk_mul_f32 v[182:183], v[182:183], v[8:9] op_sel:[0,1]
v_min_f32 v48, 0, v176
v_min_f32 v49, 0, v177
v_min_f32 v50, 0, v178
v_min_f32 v51, 0, v179
v_min_f32 v52, 0, v180
v_min_f32 v53, 0, v181
v_min_f32 v54, 0, v182
v_min_f32 v55, 0, v183
v_pk_add_f32 v[176:177], v[176:177], v[48:49] neg_lo:[0,1] neg_hi:[0,1]
v_pk_add_f32 v[178:179], v[178:179], v[50:51] neg_lo:[0,1] neg_hi:[0,1]
v_pk_add_f32 v[180:181], v[180:181], v[52:53] neg_lo:[0,1] neg_hi:[0,1]
v_pk_add_f32 v[182:183], v[182:183], v[54:55] neg_lo:[0,1] neg_hi:[0,1]
v_exp_f32 v48, v48
v_exp_f32 v49, v49
v_exp_f32 v50, v50
v_exp_f32 v51, v51
v_exp_f32 v52, v52
v_exp_f32 v53, v53
v_exp_f32 v54, v54
v_exp_f32 v55, v55
v_pk_fma_f32 v[176:177], v[176:177], v[14:15], v[14:15] op_sel:[0,0,1] op_sel_hi:[1,0,1]
v_pk_fma_f32 v[178:179], v[178:179], v[14:15], v[14:15] op_sel:[0,0,1] op_sel_hi:[1,0,1]
v_pk_fma_f32 v[180:181], v[180:181], v[14:15], v[14:15] op_sel:[0,0,1] op_sel_hi:[1,0,1]
v_pk_fma_f32 v[182:183], v[182:183], v[14:15], v[14:15] op_sel:[0,0,1] op_sel_hi:[1,0,1]
v_pk_add_f32 v[176:177], v[176:177], v[48:49]
v_pk_add_f32 v[178:179], v[178:179], v[50:51]
v_pk_add_f32 v[180:181], v[180:181], v[52:53]
v_pk_add_f32 v[182:183], v[182:183], v[54:55]
v_cvt_pk_bf16_f32 v64, v176, v177
v_cvt_pk_bf16_f32 v65, v178, v179
v_cvt_pk_bf16_f32 v66, v180, v181
v_cvt_pk_bf16_f32 v67, v182, v183
v_pk_mul_f32 v[184:185], v[184:185], v[4:5] op_sel:[0,1]
v_pk_mul_f32 v[186:187], v[186:187], v[4:5] op_sel:[0,1]
v_pk_mul_f32 v[188:189], v[188:189], v[4:5] op_sel:[0,1]
v_pk_mul_f32 v[190:191], v[190:191], v[4:5] op_sel:[0,1]
v_cvt_pk_bf16_f32 v68, v184, v185
v_cvt_pk_bf16_f32 v69, v186, v187
v_cvt_pk_bf16_f32 v70, v188, v189
v_cvt_pk_bf16_f32 v71, v190, v191
ds_write_b128 v88, v[64:67] offset:2048
v_xor_b32 v56, 32, v88
ds_write_b128 v56, v[68:71] offset:2048
s_waitcnt lgkmcnt(0)
ds_read_b64_tr_b16 v[72:73], v89 offset:4096
ds_read_b64_tr_b16 v[74:75], v90 offset:4352
ds_read_b64_tr_b16 v[76:77], v89 offset:5120
ds_read_b64_tr_b16 v[78:79], v90 offset:5376
ds_read_b64_tr_b16 v[80:81], v89 offset:6144
ds_read_b64_tr_b16 v[82:83], v90 offset:6400
ds_read_b64_tr_b16 v[84:85], v89 offset:7168
ds_read_b64_tr_b16 v[86:87], v90 offset:7424
s_waitcnt lgkmcnt(0)
v_cndmask_b32 v56, v72, v91, s[70:71]
v_cndmask_b32 v57, v73, v91, s[70:71]
v_cndmask_b32 v58, v74, v91, s[70:71]
v_cndmask_b32 v59, v75, v91, s[70:71]
s_nop 1
v_mfma_f32_32x32x16_bf16 v[128:143], v[72:75], v[56:59], 0
v_cndmask_b32 v92, v76, v91, s[70:71]
v_cndmask_b32 v93, v77, v91, s[70:71]
v_cndmask_b32 v94, v78, v91, s[70:71]
v_cndmask_b32 v95, v79, v91, s[70:71]
s_nop 1
v_mfma_f32_32x32x16_bf16 v[128:143], v[76:79], v[92:95], v[128:143]
v_cndmask_b32 v56, v80, v91, s[70:71]
v_cndmask_b32 v57, v81, v91, s[70:71]
v_cndmask_b32 v58, v82, v91, s[70:71]
v_cndmask_b32 v59, v83, v91, s[70:71]
s_nop 1
v_mfma_f32_32x32x16_bf16 v[128:143], v[80:83], v[56:59], v[128:143]
v_cndmask_b32 v92, v84, v91, s[70:71]
v_cndmask_b32 v93, v85, v91, s[70:71]
v_cndmask_b32 v94, v86, v91, s[70:71]
v_cndmask_b32 v95, v87, v91, s[70:71]
s_nop 1
v_mfma_f32_32x32x16_bf16 v[128:143], v[84:87], v[92:95], v[128:143]
v_pk_fma_f32 v[192:193], v[16:17], v[2:3], v[192:193] op_sel_hi:[1,0,1] neg_lo:[0,1,0] neg_hi:[0,1,0]
v_pk_fma_f32 v[194:195], v[18:19], v[2:3], v[194:195] op_sel_hi:[1,0,1] neg_lo:[0,1,0] neg_hi:[0,1,0]
v_pk_fma_f32 v[196:197], v[20:21], v[2:3], v[196:197] op_sel_hi:[1,0,1] neg_lo:[0,1,0] neg_hi:[0,1,0]
v_pk_fma_f32 v[198:199], v[22:23], v[2:3], v[198:199] op_sel_hi:[1,0,1] neg_lo:[0,1,0] neg_hi:[0,1,0]
v_pk_fma_f32 v[200:201], v[24:25], v[2:3], v[200:201] op_sel_hi:[1,0,1] neg_lo:[0,1,0] neg_hi:[0,1,0]
v_pk_fma_f32 v[202:203], v[26:27], v[2:3], v[202:203] op_sel_hi:[1,0,1] neg_lo:[0,1,0] neg_hi:[0,1,0]
v_pk_fma_f32 v[204:205], v[28:29], v[2:3], v[204:205] op_sel_hi:[1,0,1] neg_lo:[0,1,0] neg_hi:[0,1,0]
v_pk_fma_f32 v[206:207], v[30:31], v[2:3], v[206:207] op_sel_hi:[1,0,1] neg_lo:[0,1,0] neg_hi:[0,1,0]
v_pk_mul_f32 v[192:193], v[192:193], v[8:9] op_sel_hi:[1,0]
v_pk_mul_f32 v[194:195], v[194:195], v[8:9] op_sel_hi:[1,0]
v_pk_mul_f32 v[196:197], v[196:197], v[8:9] op_sel_hi:[1,0]
v_pk_mul_f32 v[198:199], v[198:199], v[8:9] op_sel_hi:[1,0]
v_min_f32 v48, 0, v192
v_min_f32 v49, 0, v193
v_min_f32 v50, 0, v194
v_min_f32 v51, 0, v195
v_min_f32 v52, 0, v196
v_min_f32 v53, 0, v197
v_min_f32 v54, 0, v198
v_min_f32 v55, 0, v199
v_pk_add_f32 v[192:193], v[192:193], v[48:49] neg_lo:[0,1] neg_hi:[0,1]
v_pk_add_f32 v[194:195], v[194:195], v[50:51] neg_lo:[0,1] neg_hi:[0,1]
v_pk_add_f32 v[196:197], v[196:197], v[52:53] neg_lo:[0,1] neg_hi:[0,1]
v_pk_add_f32 v[198:199], v[198:199], v[54:55] neg_lo:[0,1] neg_hi:[0,1]
v_exp_f32 v48, v48
v_exp_f32 v49, v49
v_exp_f32 v50, v50
v_exp_f32 v51, v51
v_exp_f32 v52, v52
v_exp_f32 v53, v53
v_exp_f32 v54, v54
v_exp_f32 v55, v55
v_pk_fma_f32 v[192:193], v[192:193], v[14:15], v[14:15] op_sel:[0,0,1] op_sel_hi:[1,0,1]
v_pk_fma_f32 v[194:195], v[194:195], v[14:15], v[14:15] op_sel:[0,0,1] op_sel_hi:[1,0,1]
v_pk_fma_f32 v[196:197], v[196:197], v[14:15], v[14:15] op_sel:[0,0,1] op_sel_hi:[1,0,1]
v_pk_fma_f32 v[198:199], v[198:199], v[14:15], v[14:15] op_sel:[0,0,1] op_sel_hi:[1,0,1]
v_pk_add_f32 v[192:193], v[192:193], v[48:49]
v_pk_add_f32 v[194:195], v[194:195], v[50:51]
v_pk_add_f32 v[196:197], v[196:197], v[52:53]
v_pk_add_f32 v[198:199], v[198:199], v[54:55]
v_cvt_pk_bf16_f32 v64, v192, v193
v_cvt_pk_bf16_f32 v65, v194, v195
v_cvt_pk_bf16_f32 v66, v196, v197
v_cvt_pk_bf16_f32 v67, v198, v199
v_pk_mul_f32 v[200:201], v[200:201], v[4:5] op_sel_hi:[1,0]
v_pk_mul_f32 v[202:203], v[202:203], v[4:5] op_sel_hi:[1,0]
v_pk_mul_f32 v[204:205], v[204:205], v[4:5] op_sel_hi:[1,0]
v_pk_mul_f32 v[206:207], v[206:207], v[4:5] op_sel_hi:[1,0]
v_cvt_pk_bf16_f32 v68, v200, v201
v_cvt_pk_bf16_f32 v69, v202, v203
v_cvt_pk_bf16_f32 v70, v204, v205
v_cvt_pk_bf16_f32 v71, v206, v207
ds_write_b128 v88, v[64:67] offset:4096
v_xor_b32 v56, 32, v88
ds_write_b128 v56, v[68:71] offset:4096
v_pk_fma_f32 v[208:209], v[16:17], v[2:3], v[208:209] op_sel:[0,1,0] neg_lo:[0,1,0] neg_hi:[0,1,0]
v_pk_fma_f32 v[210:211], v[18:19], v[2:3], v[210:211] op_sel:[0,1,0] neg_lo:[0,1,0] neg_hi:[0,1,0]
v_pk_fma_f32 v[212:213], v[20:21], v[2:3], v[212:213] op_sel:[0,1,0] neg_lo:[0,1,0] neg_hi:[0,1,0]
v_pk_fma_f32 v[214:215], v[22:23], v[2:3], v[214:215] op_sel:[0,1,0] neg_lo:[0,1,0] neg_hi:[0,1,0]
v_pk_fma_f32 v[216:217], v[24:25], v[2:3], v[216:217] op_sel:[0,1,0] neg_lo:[0,1,0] neg_hi:[0,1,0]
v_pk_fma_f32 v[218:219], v[26:27], v[2:3], v[218:219] op_sel:[0,1,0] neg_lo:[0,1,0] neg_hi:[0,1,0]
v_pk_fma_f32 v[220:221], v[28:29], v[2:3], v[220:221] op_sel:[0,1,0] neg_lo:[0,1,0] neg_hi:[0,1,0]
v_pk_fma_f32 v[222:223], v[30:31], v[2:3], v[222:223] op_sel:[0,1,0] neg_lo:[0,1,0] neg_hi:[0,1,0]
v_pk_mul_f32 v[208:209], v[208:209], v[8:9] op_sel:[0,1]
v_pk_mul_f32 v[210:211], v[210:211], v[8:9] op_sel:[0,1]
v_pk_mul_f32 v[212:213], v[212:213], v[8:9] op_sel:[0,1]
v_pk_mul_f32 v[214:215], v[214:215], v[8:9] op_sel:[0,1]
v_min_f32 v48, 0, v208
v_min_f32 v49, 0, v209
v_min_f32 v50, 0, v210
v_min_f32 v51, 0, v211
v_min_f32 v52, 0, v212
v_min_f32 v53, 0, v213
v_min_f32 v54, 0, v214
v_min_f32 v55, 0, v215
v_pk_add_f32 v[208:209], v[208:209], v[48:49] neg_lo:[0,1] neg_hi:[0,1]
v_pk_add_f32 v[210:211], v[210:211], v[50:51] neg_lo:[0,1] neg_hi:[0,1]
v_pk_add_f32 v[212:213], v[212:213], v[52:53] neg_lo:[0,1] neg_hi:[0,1]
v_pk_add_f32 v[214:215], v[214:215], v[54:55] neg_lo:[0,1] neg_hi:[0,1]
v_exp_f32 v48, v48
v_exp_f32 v49, v49
v_exp_f32 v50, v50
v_exp_f32 v51, v51
v_exp_f32 v52, v52
v_exp_f32 v53, v53
v_exp_f32 v54, v54
v_exp_f32 v55, v55
v_pk_fma_f32 v[208:209], v[208:209], v[14:15], v[14:15] op_sel:[0,0,1] op_sel_hi:[1,0,1]
v_pk_fma_f32 v[210:211], v[210:211], v[14:15], v[14:15] op_sel:[0,0,1] op_sel_hi:[1,0,1]
v_pk_fma_f32 v[212:213], v[212:213], v[14:15], v[14:15] op_sel:[0,0,1] op_sel_hi:[1,0,1]
v_pk_fma_f32 v[214:215], v[214:215], v[14:15], v[14:15] op_sel:[0,0,1] op_sel_hi:[1,0,1]
v_pk_add_f32 v[208:209], v[208:209], v[48:49]
v_pk_add_f32 v[210:211], v[210:211], v[50:51]
v_pk_add_f32 v[212:213], v[212:213], v[52:53]
v_pk_add_f32 v[214:215], v[214:215], v[54:55]
v_cvt_pk_bf16_f32 v64, v208, v209
v_cvt_pk_bf16_f32 v65, v210, v211
v_cvt_pk_bf16_f32 v66, v212, v213
v_cvt_pk_bf16_f32 v67, v214, v215
v_pk_mul_f32 v[216:217], v[216:217], v[4:5] op_sel:[0,1]
v_pk_mul_f32 v[218:219], v[218:219], v[4:5] op_sel:[0,1]
v_pk_mul_f32 v[220:221], v[220:221], v[4:5] op_sel:[0,1]
v_pk_mul_f32 v[222:223], v[222:223], v[4:5] op_sel:[0,1]
v_cvt_pk_bf16_f32 v68, v216, v217
v_cvt_pk_bf16_f32 v69, v218, v219
v_cvt_pk_bf16_f32 v70, v220, v221
v_cvt_pk_bf16_f32 v71, v222, v223
ds_write_b128 v88, v[64:67] offset:6144
v_xor_b32 v56, 32, v88
ds_write_b128 v56, v[68:71] offset:6144
s_waitcnt lgkmcnt(0)
ds_read_b64_tr_b16 v[72:73], v89 offset:0
ds_read_b64_tr_b16 v[74:75], v90 offset:256
ds_read_b64_tr_b16 v[76:77], v89 offset:1024
ds_read_b64_tr_b16 v[78:79], v90 offset:1280
ds_read_b64_tr_b16 v[80:81], v89 offset:2048
ds_read_b64_tr_b16 v[82:83], v90 offset:2304
ds_read_b64_tr_b16 v[84:85], v89 offset:3072
ds_read_b64_tr_b16 v[86:87], v90 offset:3328
s_waitcnt lgkmcnt(0)
v_cndmask_b32 v56, v72, v91, s[70:71]
v_cndmask_b32 v57, v73, v91, s[70:71]
v_cndmask_b32 v58, v74, v91, s[70:71]
v_cndmask_b32 v59, v75, v91, s[70:71]
s_nop 1
v_mfma_f32_32x32x16_bf16 v[160:175], v[72:75], v[56:59], 0
v_cndmask_b32 v92, v76, v91, s[70:71]
v_cndmask_b32 v93, v77, v91, s[70:71]
v_cndmask_b32 v94, v78, v91, s[70:71]
v_cndmask_b32 v95, v79, v91, s[70:71]
s_nop 1
v_mfma_f32_32x32x16_bf16 v[160:175], v[76:79], v[92:95], v[160:175]
v_cndmask_b32 v56, v80, v91, s[70:71]
v_cndmask_b32 v57, v81, v91, s[70:71]
v_cndmask_b32 v58, v82, v91, s[70:71]
v_cndmask_b32 v59, v83, v91, s[70:71]
s_nop 1
v_mfma_f32_32x32x16_bf16 v[160:175], v[80:83], v[56:59], v[160:175]
v_cndmask_b32 v92, v84, v91, s[70:71]
v_cndmask_b32 v93, v85, v91, s[70:71]
v_cndmask_b32 v94, v86, v91, s[70:71]
v_cndmask_b32 v95, v87, v91, s[70:71]
s_nop 1
v_mfma_f32_32x32x16_bf16 v[160:175], v[84:87], v[92:95], v[160:175]
s_waitcnt lgkmcnt(0)
ds_read_b64_tr_b16 v[72:73], v89 offset:4096
ds_read_b64_tr_b16 v[74:75], v90 offset:4352
ds_read_b64_tr_b16 v[76:77], v89 offset:5120
ds_read_b64_tr_b16 v[78:79], v90 offset:5376
ds_read_b64_tr_b16 v[80:81], v89 offset:6144
ds_read_b64_tr_b16 v[82:83], v90 offset:6400
ds_read_b64_tr_b16 v[84:85], v89 offset:7168
ds_read_b64_tr_b16 v[86:87], v90 offset:7424
s_waitcnt lgkmcnt(0)
v_cndmask_b32 v56, v72, v91, s[70:71]
v_cndmask_b32 v57, v73, v91, s[70:71]
v_cndmask_b32 v58, v74, v91, s[70:71]
v_cndmask_b32 v59, v75, v91, s[70:71]
s_nop 1
v_mfma_f32_32x32x16_bf16 v[192:207], v[72:75], v[56:59], 0
v_cndmask_b32 v92, v76, v91, s[70:71]
v_cndmask_b32 v93, v77, v91, s[70:71]
v_cndmask_b32 v94, v78, v91, s[70:71]
v_cndmask_b32 v95, v79, v91, s[70:71]
s_nop 1
v_mfma_f32_32x32x16_bf16 v[192:207], v[76:79], v[92:95], v[192:207]
v_cndmask_b32 v56, v80, v91, s[70:71]
v_cndmask_b32 v57, v81, v91, s[70:71]
v_cndmask_b32 v58, v82, v91, s[70:71]
v_cndmask_b32 v59, v83, v91, s[70:71]
s_nop 1
v_mfma_f32_32x32x16_bf16 v[192:207], v[80:83], v[56:59], v[192:207]
v_cndmask_b32 v92, v84, v91, s[70:71]
v_cndmask_b32 v93, v85, v91, s[70:71]
v_cndmask_b32 v94, v86, v91, s[70:71]
v_cndmask_b32 v95, v87, v91, s[70:71]
s_nop 1
v_mfma_f32_32x32x16_bf16 v[192:207], v[84:87], v[92:95], v[192:207]
v_lshlrev_b32 v48, 5, v0
s_lshl_b32 s45, s38, 13
s_add_u32 s45, s45, 53248
v_add_u32 v48, s45, v48
ds_write_b128 v48, v[96:99] offset:0
ds_write_b128 v48, v[100:103] offset:16
ds_write_b128 v48, v[128:131] offset:2048
ds_write_b128 v48, v[132:135] offset:2064
ds_write_b128 v48, v[160:163] offset:4096
ds_write_b128 v48, v[164:167] offset:4112
s_nop 1
ds_write_b128 v48, v[192:195] offset:6144
ds_write_b128 v48, v[196:199] offset:6160
s_lshl_b32 s44, s39, 16
s_lshl_b32 s45, s36, 7
s_add_u32 s44, s44, s45
s_lshl_b32 s45, s24, 4
s_add_u32 s53, s44, s45
v_and_b32 v9, 31, v0
v_lshlrev_b32 v9, 10, v9
v_lshrrev_b32 v10, 5, v0
v_lshl_add_u32 v9, v10, 3, v9
v_add_u32 v9, s53, v9
global_load_dwordx2 v[188:189], v9, s[4:5]
v_add_u32 v9, 32768, v9
global_load_dwordx2 v[190:191], v9, s[4:5]
s_lshl_b32 s44, s39, 1
s_mul_i32 s45, s44, 112
s_mul_i32 s46, s24, 14
s_add_u32 s45, s45, s46
s_lshl_b32 s45, s45, 10
s_add_u32 s62, s22, s45
s_addc_u32 s63, s23, 0
s_lshl_b32 s45, s44, 5
s_lshl_b32 s46, s24, 2
s_add_u32 s45, s45, s46
s_lshl_b32 s45, s45, 10
s_add_u32 s45, s45, 7340032
s_add_u32 s68, s22, s45
s_addc_u32 s69, s23, 0
s_mov_b32 s61, 0xf
s_cmp_eq_u32 s24, 1
s_cselect_b32 s61, 0x70c, s61
s_cmp_eq_u32 s24, 2
s_cselect_b32 s61, 0x70b00, s61
s_cmp_eq_u32 s24, 3
s_cselect_b32 s61, 0x30c0c00, s61
v_lshlrev_b32 v6, 4, v0
v_lshrrev_b32 v9, 3, v0
v_lshlrev_b32 v9, 10, v9
v_bfe_u32 v10, v0, 4, 1
v_lshlrev_b32 v10, 2, v10
v_and_b32 v1, 7, v0
v_xor_b32 v1, v1, v10
v_lshl_add_u32 v1, v1, 4, v9
s_mul_i32 s56, s24, 229376
s_lshl_b32 s44, s36, 7
s_add_u32 s56, s56, s44
s_lshl_b32 s57, s24, 16
s_add_u32 s57, s57, s44
s_mul_i32 s60, s24, 12288
v_lshrrev_b32 v9, 5, v0
v_lshlrev_b32 v9, 3, v9
v_bfe_u32 v10, v0, 2, 2
v_add_u32 v9, v9, v10
v_lshlrev_b32 v9, 7, v9
v_bfe_u32 v10, v0, 3, 1
v_lshlrev_b32 v10, 2, v10
v_bfe_u32 v11, v0, 4, 1
v_lshl_add_u32 v10, v11, 1, v10
v_bfe_u32 v11, v0, 1, 1
v_add_u32 v10, v10, v11
v_lshl_add_u32 v9, v10, 4, v9
v_and_b32 v10, 1, v0
v_lshl_add_u32 v9, v10, 3, v9
v_add_u32 v2, s60, v9
v_xor_b32 v3, 64, v2
s_add_u32 s52, s60, 106496
v_lshrrev_b32 v9, 5, v0
v_lshlrev_b32 v9, 3, v9
v_bfe_u32 v10, v0, 2, 2
v_add_u32 v9, v9, v10
v_lshlrev_b32 v9, 7, v9
v_bfe_u32 v10, v0, 3, 1
v_lshlrev_b32 v10, 2, v10
v_bfe_u32 v11, v0, 4, 1
v_lshl_add_u32 v10, v11, 1, v10
v_bfe_u32 v11, v0, 1, 1
v_add_u32 v10, v10, v11
v_lshl_add_u32 v9, v10, 4, v9
v_and_b32 v10, 1, v0
v_lshl_add_u32 v9, v10, 3, v9
v_add_u32 v4, s52, v9
v_xor_b32 v5, 64, v4
s_add_u32 s52, s60, 53248
v_mov_b32 v7, v6
v_add_u32 v8, 114688, v6
v_mov_b32 v192, 0
v_mov_b32 v193, 0
v_mov_b32 v194, 0
v_mov_b32 v195, 0
v_mov_b32 v196, 0
v_mov_b32 v197, 0
v_mov_b32 v198, 0
v_mov_b32 v199, 0
v_mov_b32 v200, 0
v_mov_b32 v201, 0
v_mov_b32 v202, 0
v_mov_b32 v203, 0
v_mov_b32 v204, 0
v_mov_b32 v205, 0
v_mov_b32 v206, 0
v_mov_b32 v207, 0
v_mov_b32 v208, 0
v_mov_b32 v209, 0
v_mov_b32 v210, 0
v_mov_b32 v211, 0
v_mov_b32 v212, 0
v_mov_b32 v213, 0
v_mov_b32 v214, 0
v_mov_b32 v215, 0
v_mov_b32 v216, 0
v_mov_b32 v217, 0
v_mov_b32 v218, 0
v_mov_b32 v219, 0
v_mov_b32 v220, 0
v_mov_b32 v221, 0
v_mov_b32 v222, 0
v_mov_b32 v223, 0
v_mov_b32 v224, 0
v_mov_b32 v225, 0
v_mov_b32 v226, 0
v_mov_b32 v227, 0
v_mov_b32 v228, 0
v_mov_b32 v229, 0
v_mov_b32 v230, 0
v_mov_b32 v231, 0
v_mov_b32 v232, 0
v_mov_b32 v233, 0
v_mov_b32 v234, 0
v_mov_b32 v235, 0
v_mov_b32 v236, 0
v_mov_b32 v237, 0
v_mov_b32 v238, 0
v_mov_b32 v239, 0
v_mov_b32 v240, 0
v_mov_b32 v241, 0
v_mov_b32 v242, 0
v_mov_b32 v243, 0
v_mov_b32 v244, 0
v_mov_b32 v245, 0
v_mov_b32 v246, 0
v_mov_b32 v247, 0
v_mov_b32 v248, 0
v_mov_b32 v249, 0
v_mov_b32 v250, 0
v_mov_b32 v251, 0
v_mov_b32 v252, 0
v_mov_b32 v253, 0
v_mov_b32 v254, 0
v_mov_b32 v255, 0
s_lshl_b32 s44, s37, 2
s_and_b32 s45, s39, 3
s_add_u32 s44, s44, s45
s_lshl_b32 s44, s44, 7
s_add_u32 s44, s44, 9474048
v_and_b32 v9, 31, v0
v_lshlrev_b32 v9, 2, v9
v_add_u32 v9, s44, v9
s_waitcnt lgkmcnt(0)
L_ep_done:
s_barrier
L_pub:
s_cmp_lg_u32 s26, 1
s_cbranch_scc1 L_pub_nokv
s_lshr_b32 s44, s24, 1
s_and_b32 s45, s24, 1
s_lshl_b32 s46, s44, 11
s_lshl_b32 s47, s45, 10
s_add_u32 s46, s46, s47
s_add_u32 s46, s46, 53760
v_lshlrev_b32 v12, 2, v0
v_add_u32 v13, s46, v12
ds_read_b32 v14, v13 offset:0
ds_read_b32 v18, v13 offset:256
ds_read_b32 v15, v13 offset:8192
ds_read_b32 v19, v13 offset:8448
ds_read_b32 v16, v13 offset:16384
ds_read_b32 v20, v13 offset:16640
ds_read_b32 v17, v13 offset:24576
ds_read_b32 v21, v13 offset:24832
v_bfe_u32 v22, v0, 3, 1
v_lshlrev_b32 v22, 10, v22
v_and_b32 v23, 7, v0
v_lshl_add_u32 v22, v23, 2, v22
s_lshl_b32 s47, s44, 11
s_add_u32 s47, s47, 53248
v_add_u32 v22, s47, v22
ds_read_b32 v24, v22 offset:0
ds_read_b32 v25, v22 offset:8192
ds_read_b32 v26, v22 offset:16384
ds_read_b32 v27, v22 offset:24576
s_lshl_b32 s46, s27, 2
s_add_u32 s46, s46, s44
s_mul_i32 s46, s46, 1152
s_add_u32 s46, s46, 9437184
s_add_u32 s66, s22, s46
s_addc_u32 s67, s23, 0
s_lshl_b32 s47, s45, 9
v_add_u32 v13, s47, v12
s_waitcnt lgkmcnt(0)
v_add_f32 v14, v14, v15
v_add_f32 v16, v16, v17
v_add_f32 v18, v18, v19
v_add_f32 v20, v20, v21
v_add_f32 v24, v24, v25
v_add_f32 v26, v26, v27
v_add_f32 v14, v14, v16
v_add_f32 v18, v18, v20
v_add_f32 v24, v24, v26
global_atomic_add_f32 v13, v14, s[66:67]
global_atomic_add_f32 v13, v18, s[66:67] offset:256
s_cmp_lg_u32 s45, 0
s_cbranch_scc1 L_pub_noz
s_mov_b64 s[64:65], exec
s_mov_b64 exec, 0xffff
global_atomic_add_f32 v12, v24, s[66:67] offset:1024
s_mov_b64 exec, s[64:65]
L_pub_noz:
L_pub_nokv:
s_barrier
s_cmp_ge_u32 s24, 4
s_cbranch_scc1 L_g2_l
s_add_u32 m0, s52, 0
s_add_u32 s44, s56, 196608
buffer_load_dwordx4 v1, s[28:31], s44 offen lds
s_add_u32 m0, s52, 1024
s_add_u32 s44, s56, 204800
buffer_load_dwordx4 v1, s[28:31], s44 offen lds
s_add_u32 m0, s52, 2048
s_add_u32 s44, s56, 212992
buffer_load_dwordx4 v1, s[28:31], s44 offen lds
s_add_u32 m0, s52, 3072
s_add_u32 s44, s56, 221184
buffer_load_dwordx4 v1, s[28:31], s44 offen lds
s_add_u32 m0, s52, 4096
s_add_u32 s44, s57, 0
buffer_load_dwordx4 v1, s[32:35], s44 offen lds
s_add_u32 m0, s52, 5120
s_add_u32 s44, s57, 8192
buffer_load_dwordx4 v1, s[32:35], s44 offen lds
s_add_u32 m0, s52, 6144
s_add_u32 s44, s57, 16384
buffer_load_dwordx4 v1, s[32:35], s44 offen lds
s_add_u32 m0, s52, 7168
s_add_u32 s44, s57, 24576
buffer_load_dwordx4 v1, s[32:35], s44 offen lds
s_add_u32 m0, s52, 8192
s_add_u32 s44, s57, 32768
buffer_load_dwordx4 v1, s[32:35], s44 offen lds
s_add_u32 m0, s52, 9216
s_add_u32 s44, s57, 40960
buffer_load_dwordx4 v1, s[32:35], s44 offen lds
s_add_u32 m0, s52, 10240
s_add_u32 s44, s57, 49152
buffer_load_dwordx4 v1, s[32:35], s44 offen lds
s_add_u32 m0, s52, 11264
s_add_u32 s44, s57, 57344
buffer_load_dwordx4 v1, s[32:35], s44 offen lds
s_cmp_lg_u32 s26, 1
s_cbranch_scc1 L_g2_nokvfc
s_waitcnt vmcnt(12)
s_lshl_b32 s44, s27, 8
s_lshl_b32 s45, s25, 5
s_add_u32 s44, s44, s45
s_lshl_b32 s45, s24, 2
s_add_u32 s44, s44, s45
s_add_u32 s44, s44, 9478144
v_mov_b32 v10, s44
v_mov_b32 v11, 1
s_mov_b64 s[64:65], exec
s_mov_b64 exec, 1
global_store_dword v10, v11, s[22:23] sc1
s_mov_b64 exec, s[64:65]
L_g2_nokvfc:
s_mov_b32 s46, 0
L_poll_hc:
global_load_dword v10, v9, s[22:23] sc1
s_waitcnt vmcnt(0)
s_add_u32 s46, s46, 1
v_cmp_ne_u32 vcc, 0, v10
s_nop 3
s_and_b32 s47, vcc_lo, s61
s_cmp_eq_u32 s47, s61
s_cbranch_scc1 L_pollok_hc
s_cmp_lt_u32 s46, 400000
s_cbranch_scc1 L_poll_hc
L_pollok_hc:
v_mov_b32 v10, v6
v_add_u32 v11, 32768, v6
global_load_dwordx4 v[12:15], v7, s[62:63] offset:0 sc1
global_load_dwordx4 v[16:19], v8, s[62:63] offset:0 sc1
global_load_dwordx4 v[20:23], v7, s[62:63] offset:1024 sc1
global_load_dwordx4 v[24:27], v8, s[62:63] offset:1024 sc1
global_load_dwordx4 v[28:31], v7, s[62:63] offset:2048 sc1
global_load_dwordx4 v[32:35], v8, s[62:63] offset:2048 sc1
global_load_dwordx4 v[36:39], v7, s[62:63] offset:3072 sc1
global_load_dwordx4 v[40:43], v8, s[62:63] offset:3072 sc1
v_add_u32 v7, 4096, v7
v_add_u32 v8, 4096, v8
global_load_dwordx4 v[44:47], v7, s[62:63] offset:0 sc1
global_load_dwordx4 v[48:51], v8, s[62:63] offset:0 sc1
global_load_dwordx4 v[52:55], v7, s[62:63] offset:1024 sc1
global_load_dwordx4 v[56:59], v8, s[62:63] offset:1024 sc1
global_load_dwordx4 v[60:63], v7, s[62:63] offset:2048 sc1
global_load_dwordx4 v[64:67], v8, s[62:63] offset:2048 sc1
global_load_dwordx4 v[68:71], v7, s[62:63] offset:3072 sc1
global_load_dwordx4 v[72:75], v8, s[62:63] offset:3072 sc1
s_lshl_b32 s44, s24, 8
s_add_u32 s44, s44, 9478144
v_lshlrev_b32 v177, 2, v0
v_add_u32 v177, s44, v177
ds_read_b64_tr_b16 v[160:161], v2 offset:0
ds_read_b64_tr_b16 v[162:163], v2 offset:512
ds_read_b64_tr_b16 v[164:165], v3 offset:0
ds_read_b64_tr_b16 v[166:167], v3 offset:512
s_waitcnt vmcnt(14)
s_waitcnt lgkmcnt(0)
ds_read_b64_tr_b16 v[168:169], v2 offset:2048
ds_read_b64_tr_b16 v[170:171], v2 offset:2560
ds_read_b64_tr_b16 v[172:173], v3 offset:2048
ds_read_b64_tr_b16 v[174:175], v3 offset:2560
v_mfma_f32_32x32x16_bf16 v[192:207], v[160:163], v[12:15], v[192:207]
v_mfma_f32_32x32x16_bf16 v[208:223], v[160:163], v[16:19], v[208:223]
v_mfma_f32_32x32x16_bf16 v[224:239], v[164:167], v[12:15], v[224:239]
v_mfma_f32_32x32x16_bf16 v[240:255], v[164:167], v[16:19], v[240:255]
v_add_u32 v7, 4096, v7
v_add_u32 v8, 4096, v8
global_load_dwordx4 v[76:79], v7, s[62:63] offset:0 sc1
global_load_dwordx4 v[80:83], v8, s[62:63] offset:0 sc1
s_waitcnt vmcnt(14)
s_waitcnt lgkmcnt(0)
ds_read_b64_tr_b16 v[160:161], v2 offset:4096
ds_read_b64_tr_b16 v[162:163], v2 offset:4608
ds_read_b64_tr_b16 v[164:165], v3 offset:4096
ds_read_b64_tr_b16 v[166:167], v3 offset:4608
v_mfma_f32_32x32x16_bf16 v[192:207], v[168:171], v[20:23], v[192:207]
v_mfma_f32_32x32x16_bf16 v[208:223], v[168:171], v[24:27], v[208:223]
v_mfma_f32_32x32x16_bf16 v[224:239], v[172:175], v[20:23], v[224:239]
v_mfma_f32_32x32x16_bf16 v[240:255], v[172:175], v[24:27], v[240:255]
global_load_dwordx4 v[84:87], v7, s[62:63] offset:1024 sc1
global_load_dwordx4 v[88:91], v8, s[62:63] offset:1024 sc1
s_waitcnt vmcnt(14)
s_waitcnt lgkmcnt(0)
ds_read_b64_tr_b16 v[168:169], v2 offset:6144
ds_read_b64_tr_b16 v[170:171], v2 offset:6656
ds_read_b64_tr_b16 v[172:173], v3 offset:6144
ds_read_b64_tr_b16 v[174:175], v3 offset:6656
v_mfma_f32_32x32x16_bf16 v[192:207], v[160:163], v[28:31], v[192:207]
v_mfma_f32_32x32x16_bf16 v[208:223], v[160:163], v[32:35], v[208:223]
v_mfma_f32_32x32x16_bf16 v[224:239], v[164:167], v[28:31], v[224:239]
v_mfma_f32_32x32x16_bf16 v[240:255], v[164:167], v[32:35], v[240:255]
global_load_dwordx4 v[92:95], v7, s[62:63] offset:2048 sc1
global_load_dwordx4 v[96:99], v8, s[62:63] offset:2048 sc1
s_waitcnt vmcnt(14)
s_waitcnt lgkmcnt(0)
ds_read_b64_tr_b16 v[160:161], v2 offset:8192
ds_read_b64_tr_b16 v[162:163], v2 offset:8704
ds_read_b64_tr_b16 v[164:165], v3 offset:8192
ds_read_b64_tr_b16 v[166:167], v3 offset:8704
v_mfma_f32_32x32x16_bf16 v[192:207], v[168:171], v[36:39], v[192:207]
v_mfma_f32_32x32x16_bf16 v[208:223], v[168:171], v[40:43], v[208:223]
v_mfma_f32_32x32x16_bf16 v[224:239], v[172:175], v[36:39], v[224:239]
v_mfma_f32_32x32x16_bf16 v[240:255], v[172:175], v[40:43], v[240:255]
global_load_dwordx4 v[100:103], v7, s[62:63] offset:3072 sc1
global_load_dwordx4 v[104:107], v8, s[62:63] offset:3072 sc1
s_waitcnt vmcnt(14)
s_waitcnt lgkmcnt(0)
ds_read_b64_tr_b16 v[168:169], v2 offset:10240
ds_read_b64_tr_b16 v[170:171], v2 offset:10752
ds_read_b64_tr_b16 v[172:173], v3 offset:10240
ds_read_b64_tr_b16 v[174:175], v3 offset:10752
v_mfma_f32_32x32x16_bf16 v[192:207], v[160:163], v[44:47], v[192:207]
v_mfma_f32_32x32x16_bf16 v[208:223], v[160:163], v[48:51], v[208:223]
v_mfma_f32_32x32x16_bf16 v[224:239], v[164:167], v[44:47], v[224:239]
v_mfma_f32_32x32x16_bf16 v[240:255], v[164:167], v[48:51], v[240:255]
v_add_u32 v7, 4096, v7
v_add_u32 v8, 4096, v8
global_load_dwordx4 v[108:111], v7, s[62:63] offset:0 sc1
global_load_dwordx4 v[112:115], v8, s[62:63] offset:0 sc1
s_waitcnt vmcnt(14)
s_waitcnt lgkmcnt(0)
ds_read_b64_tr_b16 v[160:161], v4 offset:0
ds_read_b64_tr_b16 v[162:163], v4 offset:512
ds_read_b64_tr_b16 v[164:165], v5 offset:0
ds_read_b64_tr_b16 v[166:167], v5 offset:512
v_mfma_f32_32x32x16_bf16 v[192:207], v[168:171], v[52:55], v[192:207]
v_mfma_f32_32x32x16_bf16 v[208:223], v[168:171], v[56:59], v[208:223]
v_mfma_f32_32x32x16_bf16 v[224:239], v[172:175], v[52:55], v[224:239]
v_mfma_f32_32x32x16_bf16 v[240:255], v[172:175], v[56:59], v[240:255]
global_load_dwordx4 v[116:119], v7, s[62:63] offset:1024 sc1
global_load_dwordx4 v[120:123], v8, s[62:63] offset:1024 sc1
s_waitcnt vmcnt(14)
s_waitcnt lgkmcnt(0)
ds_read_b64_tr_b16 v[168:169], v4 offset:2048
ds_read_b64_tr_b16 v[170:171], v4 offset:2560
ds_read_b64_tr_b16 v[172:173], v5 offset:2048
ds_read_b64_tr_b16 v[174:175], v5 offset:2560
v_mfma_f32_32x32x16_bf16 v[192:207], v[160:163], v[60:63], v[192:207]
v_mfma_f32_32x32x16_bf16 v[208:223], v[160:163], v[64:67], v[208:223]
v_mfma_f32_32x32x16_bf16 v[224:239], v[164:167], v[60:63], v[224:239]
v_mfma_f32_32x32x16_bf16 v[240:255], v[164:167], v[64:67], v[240:255]
global_load_dwordx4 v[124:127], v10, s[68:69] offset:0 sc1
global_load_dwordx4 v[128:131], v11, s[68:69] offset:0 sc1
s_waitcnt vmcnt(14)
s_waitcnt lgkmcnt(0)
ds_read_b64_tr_b16 v[160:161], v4 offset:4096
ds_read_b64_tr_b16 v[162:163], v4 offset:4608
ds_read_b64_tr_b16 v[164:165], v5 offset:4096
ds_read_b64_tr_b16 v[166:167], v5 offset:4608
v_mfma_f32_32x32x16_bf16 v[192:207], v[168:171], v[68:71], v[192:207]
v_mfma_f32_32x32x16_bf16 v[208:223], v[168:171], v[72:75], v[208:223]
v_mfma_f32_32x32x16_bf16 v[224:239], v[172:175], v[68:71], v[224:239]
v_mfma_f32_32x32x16_bf16 v[240:255], v[172:175], v[72:75], v[240:255]
global_load_dwordx4 v[132:135], v10, s[68:69] offset:1024 sc1
global_load_dwordx4 v[136:139], v11, s[68:69] offset:1024 sc1
global_load_dword v176, v177, s[22:23] sc1
s_waitcnt vmcnt(15)
s_waitcnt lgkmcnt(0)
ds_read_b64_tr_b16 v[168:169], v4 offset:6144
ds_read_b64_tr_b16 v[170:171], v4 offset:6656
ds_read_b64_tr_b16 v[172:173], v5 offset:6144
ds_read_b64_tr_b16 v[174:175], v5 offset:6656
v_mfma_f32_32x32x16_bf16 v[192:207], v[160:163], v[76:79], v[192:207]
v_mfma_f32_32x32x16_bf16 v[208:223], v[160:163], v[80:83], v[208:223]
v_mfma_f32_32x32x16_bf16 v[224:239], v[164:167], v[76:79], v[224:239]
v_mfma_f32_32x32x16_bf16 v[240:255], v[164:167], v[80:83], v[240:255]
global_load_dwordx4 v[140:143], v10, s[68:69] offset:2048 sc1
global_load_dwordx4 v[144:147], v11, s[68:69] offset:2048 sc1
s_waitcnt vmcnt(15)
s_waitcnt lgkmcnt(0)
ds_read_b64_tr_b16 v[160:161], v4 offset:8192
ds_read_b64_tr_b16 v[162:163], v4 offset:8704
ds_read_b64_tr_b16 v[164:165], v5 offset:8192
ds_read_b64_tr_b16 v[166:167], v5 offset:8704
v_mfma_f32_32x32x16_bf16 v[192:207], v[168:171], v[84:87], v[192:207]
v_mfma_f32_32x32x16_bf16 v[208:223], v[168:171], v[88:91], v[208:223]
v_mfma_f32_32x32x16_bf16 v[224:239], v[172:175], v[84:87], v[224:239]
v_mfma_f32_32x32x16_bf16 v[240:255], v[172:175], v[88:91], v[240:255]
global_load_dwordx4 v[148:151], v10, s[68:69] offset:3072 sc1
global_load_dwordx4 v[152:155], v11, s[68:69] offset:3072 sc1
s_waitcnt vmcnt(15)
s_waitcnt lgkmcnt(0)
ds_read_b64_tr_b16 v[168:169], v4 offset:10240
ds_read_b64_tr_b16 v[170:171], v4 offset:10752
ds_read_b64_tr_b16 v[172:173], v5 offset:10240
ds_read_b64_tr_b16 v[174:175], v5 offset:10752
v_mfma_f32_32x32x16_bf16 v[192:207], v[160:163], v[92:95], v[192:207]
v_mfma_f32_32x32x16_bf16 v[208:223], v[160:163], v[96:99], v[208:223]
v_mfma_f32_32x32x16_bf16 v[224:239], v[164:167], v[92:95], v[224:239]
v_mfma_f32_32x32x16_bf16 v[240:255], v[164:167], v[96:99], v[240:255]
s_waitcnt vmcnt(4)
v_cmp_ne_u32 vcc, 0, v176
s_nop 3
s_not_b64 vcc, vcc
s_cmp_eq_u64 vcc, 0
s_cbranch_scc1 L_kv_readyc
s_mov_b32 s46, 0
L_poll_kvc:
global_load_dword v176, v177, s[22:23] sc1
s_waitcnt vmcnt(0)
s_add_u32 s46, s46, 1
v_cmp_ne_u32 vcc, 0, v176
s_nop 3
s_not_b64 vcc, vcc
s_cmp_eq_u64 vcc, 0
s_cbranch_scc1 L_pollok_kvc
s_cmp_lt_u32 s46, 400000
s_cbranch_scc1 L_poll_kvc
L_pollok_kvc:
L_kv_readyc:
v_lshrrev_b32 v9, 5, v0
v_and_b32 v10, 15, v0
v_lshlrev_b32 v10, 5, v10
v_lshl_add_u32 v10, v9, 9, v10
v_lshlrev_b32 v9, 5, v9
v_add_u32 v9, 1024, v9
v_and_b32 v11, 16, v0
v_cmp_eq_u32 vcc, 0, v11
s_mul_i32 s44, s24, 4608
s_add_u32 s44, s44, 9437184
v_cndmask_b32 v9, v10, v9, vcc
s_add_u32 s66, s22, s44
s_addc_u32 s67, s23, 0
global_load_dwordx4 v[12:15], v9, s[66:67] offset:0 sc1
global_load_dwordx4 v[16:19], v9, s[66:67] offset:16 sc1
global_load_dwordx4 v[20:23], v9, s[66:67] offset:1152 sc1
global_load_dwordx4 v[24:27], v9, s[66:67] offset:1168 sc1
global_load_dwordx4 v[28:31], v9, s[66:67] offset:2304 sc1
global_load_dwordx4 v[32:35], v9, s[66:67] offset:2320 sc1
global_load_dwordx4 v[36:39], v9, s[66:67] offset:3456 sc1
global_load_dwordx4 v[40:43], v9, s[66:67] offset:3472 sc1
s_waitcnt vmcnt(21)
s_waitcnt lgkmcnt(0)
ds_read_b64_tr_b16 v[160:161], v2 offset:53248
ds_read_b64_tr_b16 v[162:163], v2 offset:53760
ds_read_b64_tr_b16 v[164:165], v3 offset:53248
ds_read_b64_tr_b16 v[166:167], v3 offset:53760
v_mfma_f32_32x32x16_bf16 v[192:207], v[168:171], v[100:103], v[192:207]
v_mfma_f32_32x32x16_bf16 v[208:223], v[168:171], v[104:107], v[208:223]
v_mfma_f32_32x32x16_bf16 v[224:239], v[172:175], v[100:103], v[224:239]
v_mfma_f32_32x32x16_bf16 v[240:255], v[172:175], v[104:107], v[240:255]
s_waitcnt vmcnt(19)
s_waitcnt lgkmcnt(0)
ds_read_b64_tr_b16 v[168:169], v2 offset:55296
ds_read_b64_tr_b16 v[170:171], v2 offset:55808
ds_read_b64_tr_b16 v[172:173], v3 offset:55296
ds_read_b64_tr_b16 v[174:175], v3 offset:55808
v_mfma_f32_32x32x16_bf16 v[192:207], v[160:163], v[108:111], v[192:207]
v_mfma_f32_32x32x16_bf16 v[208:223], v[160:163], v[112:115], v[208:223]
v_mfma_f32_32x32x16_bf16 v[224:239], v[164:167], v[108:111], v[224:239]
v_mfma_f32_32x32x16_bf16 v[240:255], v[164:167], v[112:115], v[240:255]
s_waitcnt vmcnt(17)
s_waitcnt lgkmcnt(0)
ds_read_b64_tr_b16 v[160:161], v2 offset:57344
ds_read_b64_tr_b16 v[162:163], v2 offset:57856
ds_read_b64_tr_b16 v[164:165], v3 offset:57344
ds_read_b64_tr_b16 v[166:167], v3 offset:57856
v_mfma_f32_32x32x16_bf16 v[192:207], v[168:171], v[116:119], v[192:207]
v_mfma_f32_32x32x16_bf16 v[208:223], v[168:171], v[120:123], v[208:223]
v_mfma_f32_32x32x16_bf16 v[224:239], v[172:175], v[116:119], v[224:239]
v_mfma_f32_32x32x16_bf16 v[240:255], v[172:175], v[120:123], v[240:255]
s_mov_b32 s46, 0x358637bd
s_waitcnt vmcnt(0)
v_cvt_pk_bf16_f32 v44, v12, v13
v_cvt_pk_bf16_f32 v45, v14, v15
v_cvt_pk_bf16_f32 v46, v16, v17
v_cvt_pk_bf16_f32 v47, v18, v19
v_cvt_pk_bf16_f32 v48, v20, v21
v_cvt_pk_bf16_f32 v49, v22, v23
v_cvt_pk_bf16_f32 v50, v24, v25
v_cvt_pk_bf16_f32 v51, v26, v27
v_cvt_pk_bf16_f32 v52, v28, v29
v_cvt_pk_bf16_f32 v53, v30, v31
v_cvt_pk_bf16_f32 v54, v32, v33
v_cvt_pk_bf16_f32 v55, v34, v35
v_cvt_pk_bf16_f32 v56, v36, v37
v_cvt_pk_bf16_f32 v57, v38, v39
v_cvt_pk_bf16_f32 v58, v40, v41
v_cvt_pk_bf16_f32 v59, v42, v43
s_waitcnt vmcnt(8)
v_mfma_f32_32x32x16_bf16 v[60:75], v[44:47], v[124:127], 0
v_mfma_f32_32x32x16_bf16 v[76:91], v[44:47], v[128:131], 0
v_mfma_f32_32x32x16_bf16 v[92:107], v[48:51], v[132:135], 0
v_mfma_f32_32x32x16_bf16 v[108:123], v[48:51], v[136:139], 0
s_waitcnt lgkmcnt(0)
ds_read_b64_tr_b16 v[168:169], v2 offset:59392
ds_read_b64_tr_b16 v[170:171], v2 offset:59904
ds_read_b64_tr_b16 v[172:173], v3 offset:59392
ds_read_b64_tr_b16 v[174:175], v3 offset:59904
s_nop 3
v_add_f32 v9, s46, v60
v_add_f32 v10, s46, v76
v_rcp_f32 v9, v9
v_rcp_f32 v10, v10
v_mul_f32 v68, v9, v68
v_mul_f32 v69, v9, v69
v_mul_f32 v70, v9, v70
v_mul_f32 v71, v9, v71
v_mul_f32 v72, v9, v72
v_mul_f32 v73, v9, v73
v_mul_f32 v74, v9, v74
v_mul_f32 v75, v9, v75
v_mul_f32 v84, v10, v84
v_mul_f32 v85, v10, v85
v_mul_f32 v86, v10, v86
v_mul_f32 v87, v10, v87
v_mul_f32 v88, v10, v88
v_mul_f32 v89, v10, v89
v_mul_f32 v90, v10, v90
v_mul_f32 v91, v10, v91
v_cvt_pk_bf16_f32 v60, v68, v69
v_cvt_pk_bf16_f32 v61, v70, v71
v_cvt_pk_bf16_f32 v62, v72, v73
v_cvt_pk_bf16_f32 v63, v74, v75
v_cvt_pk_bf16_f32 v76, v84, v85
v_cvt_pk_bf16_f32 v77, v86, v87
v_cvt_pk_bf16_f32 v78, v88, v89
v_cvt_pk_bf16_f32 v79, v90, v91
v_mfma_f32_32x32x16_bf16 v[192:207], v[160:163], v[60:63], v[192:207]
s_nop 0
v_mfma_f32_32x32x16_bf16 v[208:223], v[160:163], v[76:79], v[208:223]
v_mfma_f32_32x32x16_bf16 v[224:239], v[164:167], v[60:63], v[224:239]
v_mfma_f32_32x32x16_bf16 v[240:255], v[164:167], v[76:79], v[240:255]
v_mfma_f32_32x32x16_bf16 v[60:75], v[52:55], v[140:143], 0
v_mfma_f32_32x32x16_bf16 v[76:91], v[52:55], v[144:147], 0
s_waitcnt lgkmcnt(0)
ds_read_b64_tr_b16 v[160:161], v2 offset:61440
ds_read_b64_tr_b16 v[162:163], v2 offset:61952
ds_read_b64_tr_b16 v[164:165], v3 offset:61440
ds_read_b64_tr_b16 v[166:167], v3 offset:61952
v_add_f32 v9, s46, v92
v_add_f32 v10, s46, v108
v_rcp_f32 v9, v9
v_rcp_f32 v10, v10
v_mul_f32 v100, v9, v100
v_mul_f32 v101, v9, v101
v_mul_f32 v102, v9, v102
v_mul_f32 v103, v9, v103
v_mul_f32 v104, v9, v104
v_mul_f32 v105, v9, v105
v_mul_f32 v106, v9, v106
v_mul_f32 v107, v9, v107
v_mul_f32 v116, v10, v116
v_mul_f32 v117, v10, v117
v_mul_f32 v118, v10, v118
v_mul_f32 v119, v10, v119
v_mul_f32 v120, v10, v120
v_mul_f32 v121, v10, v121
v_mul_f32 v122, v10, v122
v_mul_f32 v123, v10, v123
v_cvt_pk_bf16_f32 v92, v100, v101
v_cvt_pk_bf16_f32 v93, v102, v103
v_cvt_pk_bf16_f32 v94, v104, v105
v_cvt_pk_bf16_f32 v95, v106, v107
v_cvt_pk_bf16_f32 v108, v116, v117
v_cvt_pk_bf16_f32 v109, v118, v119
v_cvt_pk_bf16_f32 v110, v120, v121
v_cvt_pk_bf16_f32 v111, v122, v123
v_mfma_f32_32x32x16_bf16 v[192:207], v[168:171], v[92:95], v[192:207]
s_nop 0
v_mfma_f32_32x32x16_bf16 v[208:223], v[168:171], v[108:111], v[208:223]
v_mfma_f32_32x32x16_bf16 v[224:239], v[172:175], v[92:95], v[224:239]
v_mfma_f32_32x32x16_bf16 v[240:255], v[172:175], v[108:111], v[240:255]
v_mfma_f32_32x32x16_bf16 v[92:107], v[56:59], v[148:151], 0
v_mfma_f32_32x32x16_bf16 v[108:123], v[56:59], v[152:155], 0
s_waitcnt lgkmcnt(0)
ds_read_b64_tr_b16 v[168:169], v2 offset:63488
ds_read_b64_tr_b16 v[170:171], v2 offset:64000
ds_read_b64_tr_b16 v[172:173], v3 offset:63488
ds_read_b64_tr_b16 v[174:175], v3 offset:64000
v_add_f32 v9, s46, v60
v_add_f32 v10, s46, v76
v_rcp_f32 v9, v9
v_rcp_f32 v10, v10
v_mul_f32 v68, v9, v68
v_mul_f32 v69, v9, v69
v_mul_f32 v70, v9, v70
v_mul_f32 v71, v9, v71
v_mul_f32 v72, v9, v72
v_mul_f32 v73, v9, v73
v_mul_f32 v74, v9, v74
v_mul_f32 v75, v9, v75
v_mul_f32 v84, v10, v84
v_mul_f32 v85, v10, v85
v_mul_f32 v86, v10, v86
v_mul_f32 v87, v10, v87
v_mul_f32 v88, v10, v88
v_mul_f32 v89, v10, v89
v_mul_f32 v90, v10, v90
v_mul_f32 v91, v10, v91
v_cvt_pk_bf16_f32 v60, v68, v69
v_cvt_pk_bf16_f32 v61, v70, v71
v_cvt_pk_bf16_f32 v62, v72, v73
v_cvt_pk_bf16_f32 v63, v74, v75
v_cvt_pk_bf16_f32 v76, v84, v85
v_cvt_pk_bf16_f32 v77, v86, v87
v_cvt_pk_bf16_f32 v78, v88, v89
v_cvt_pk_bf16_f32 v79, v90, v91
v_mfma_f32_32x32x16_bf16 v[192:207], v[160:163], v[60:63], v[192:207]
s_nop 0
v_mfma_f32_32x32x16_bf16 v[208:223], v[160:163], v[76:79], v[208:223]
v_mfma_f32_32x32x16_bf16 v[224:239], v[164:167], v[60:63], v[224:239]
v_mfma_f32_32x32x16_bf16 v[240:255], v[164:167], v[76:79], v[240:255]
s_waitcnt lgkmcnt(0)
v_add_f32 v9, s46, v92
v_add_f32 v10, s46, v108
v_rcp_f32 v9, v9
v_rcp_f32 v10, v10
v_mul_f32 v100, v9, v100
v_mul_f32 v101, v9, v101
v_mul_f32 v102, v9, v102
v_mul_f32 v103, v9, v103
v_mul_f32 v104, v9, v104
v_mul_f32 v105, v9, v105
v_mul_f32 v106, v9, v106
v_mul_f32 v107, v9, v107
v_mul_f32 v116, v10, v116
v_mul_f32 v117, v10, v117
v_mul_f32 v118, v10, v118
v_mul_f32 v119, v10, v119
v_mul_f32 v120, v10, v120
v_mul_f32 v121, v10, v121
v_mul_f32 v122, v10, v122
v_mul_f32 v123, v10, v123
v_cvt_pk_bf16_f32 v92, v100, v101
v_cvt_pk_bf16_f32 v93, v102, v103
v_cvt_pk_bf16_f32 v94, v104, v105
v_cvt_pk_bf16_f32 v95, v106, v107
v_cvt_pk_bf16_f32 v108, v116, v117
v_cvt_pk_bf16_f32 v109, v118, v119
v_cvt_pk_bf16_f32 v110, v120, v121
v_cvt_pk_bf16_f32 v111, v122, v123
v_mfma_f32_32x32x16_bf16 v[192:207], v[168:171], v[92:95], v[192:207]
s_nop 0
v_mfma_f32_32x32x16_bf16 v[208:223], v[168:171], v[108:111], v[208:223]
v_mfma_f32_32x32x16_bf16 v[224:239], v[172:175], v[92:95], v[224:239]
v_mfma_f32_32x32x16_bf16 v[240:255], v[172:175], v[108:111], v[240:255]
v_mov_b32 v116, v188
v_mov_b32 v117, v189
v_mov_b32 v118, v190
v_mov_b32 v119, v191
s_waitcnt lgkmcnt(0)
s_and_b32 s45, s24, 3
s_mul_i32 s45, s45, 12288
v_lshlrev_b32 v9, 4, v0
v_add_u32 v9, s45, v9
v_add_u32 v10, 106496, v9
v_add_u32 v11, 53248, v9
ds_write_b128 v9, v[192:195] offset:0
ds_write_b128 v9, v[196:199] offset:1024
ds_write_b128 v9, v[200:203] offset:2048
ds_write_b128 v9, v[204:207] offset:3072
ds_write_b128 v9, v[224:227] offset:4096
ds_write_b128 v9, v[228:231] offset:5120
ds_write_b128 v9, v[232:235] offset:6144
ds_write_b128 v9, v[236:239] offset:7168
ds_write_b128 v10, v[208:211] offset:0
ds_write_b128 v10, v[212:215] offset:1024
ds_write_b128 v10, v[216:219] offset:2048
ds_write_b128 v10, v[220:223] offset:3072
ds_write_b128 v10, v[240:243] offset:4096
ds_write_b128 v10, v[244:247] offset:5120
ds_write_b128 v10, v[248:251] offset:6144
ds_write_b128 v10, v[252:255] offset:7168
s_barrier
s_branch L_g2_fin
L_g2_l:
s_cmp_lg_u32 s26, 1
s_cbranch_scc1 L_g2_nokvfl
s_waitcnt vmcnt(0)
s_lshl_b32 s44, s27, 8
s_lshl_b32 s45, s25, 5
s_add_u32 s44, s44, s45
s_lshl_b32 s45, s24, 2
s_add_u32 s44, s44, s45
s_add_u32 s44, s44, 9478144
v_mov_b32 v10, s44
v_mov_b32 v11, 1
s_mov_b64 s[64:65], exec
s_mov_b64 exec, 1
global_store_dword v10, v11, s[22:23] sc1
s_mov_b64 exec, s[64:65]
L_g2_nokvfl:
s_mov_b32 s46, 0
L_poll_hl:
global_load_dword v10, v9, s[22:23] sc1
s_waitcnt vmcnt(0)
s_add_u32 s46, s46, 1
v_cmp_ne_u32 vcc, 0, v10
s_nop 3
s_and_b32 s47, vcc_lo, s61
s_cmp_eq_u32 s47, s61
s_cbranch_scc1 L_pollok_hl
s_cmp_lt_u32 s46, 400000
s_cbranch_scc1 L_poll_hl
L_pollok_hl:
v_mov_b32 v10, v6
v_add_u32 v11, 32768, v6
global_load_dwordx4 v[12:15], v7, s[62:63] offset:0 sc1
global_load_dwordx4 v[16:19], v8, s[62:63] offset:0 sc1
global_load_dwordx4 v[20:23], v7, s[62:63] offset:1024 sc1
global_load_dwordx4 v[24:27], v8, s[62:63] offset:1024 sc1
global_load_dwordx4 v[28:31], v7, s[62:63] offset:2048 sc1
global_load_dwordx4 v[32:35], v8, s[62:63] offset:2048 sc1
global_load_dwordx4 v[36:39], v7, s[62:63] offset:3072 sc1
global_load_dwordx4 v[40:43], v8, s[62:63] offset:3072 sc1
s_lshl_b32 s44, s24, 8
s_add_u32 s44, s44, 9478144
v_lshlrev_b32 v2, 2, v0
v_add_u32 v2, s44, v2
s_waitcnt vmcnt(6)
v_mfma_f32_32x32x16_bf16 v[192:207], v[48:51], v[12:15], v[192:207]
v_mfma_f32_32x32x16_bf16 v[208:223], v[48:51], v[16:19], v[208:223]
v_mfma_f32_32x32x16_bf16 v[224:239], v[52:55], v[12:15], v[224:239]
v_mfma_f32_32x32x16_bf16 v[240:255], v[52:55], v[16:19], v[240:255]
v_add_u32 v7, 4096, v7
v_add_u32 v8, 4096, v8
global_load_dwordx4 v[12:15], v7, s[62:63] offset:0 sc1
global_load_dwordx4 v[16:19], v8, s[62:63] offset:0 sc1
global_load_dwordx4 v[48:51], v7, s[62:63] offset:1024 sc1
global_load_dwordx4 v[52:55], v8, s[62:63] offset:1024 sc1
s_waitcnt vmcnt(8)
v_mfma_f32_32x32x16_bf16 v[192:207], v[56:59], v[20:23], v[192:207]
v_mfma_f32_32x32x16_bf16 v[208:223], v[56:59], v[24:27], v[208:223]
v_mfma_f32_32x32x16_bf16 v[224:239], v[60:63], v[20:23], v[224:239]
v_mfma_f32_32x32x16_bf16 v[240:255], v[60:63], v[24:27], v[240:255]
global_load_dwordx4 v[20:23], v7, s[62:63] offset:2048 sc1
global_load_dwordx4 v[24:27], v8, s[62:63] offset:2048 sc1
global_load_dwordx4 v[56:59], v7, s[62:63] offset:3072 sc1
global_load_dwordx4 v[60:63], v8, s[62:63] offset:3072 sc1
s_waitcnt vmcnt(10)
v_mfma_f32_32x32x16_bf16 v[192:207], v[64:67], v[28:31], v[192:207]
v_mfma_f32_32x32x16_bf16 v[208:223], v[64:67], v[32:35], v[208:223]
v_mfma_f32_32x32x16_bf16 v[224:239], v[68:71], v[28:31], v[224:239]
v_mfma_f32_32x32x16_bf16 v[240:255], v[68:71], v[32:35], v[240:255]
v_add_u32 v7, 4096, v7
v_add_u32 v8, 4096, v8
global_load_dwordx4 v[28:31], v7, s[62:63] offset:0 sc1
global_load_dwordx4 v[32:35], v8, s[62:63] offset:0 sc1
global_load_dwordx4 v[64:67], v7, s[62:63] offset:1024 sc1
global_load_dwordx4 v[68:71], v8, s[62:63] offset:1024 sc1
s_waitcnt vmcnt(12)
v_mfma_f32_32x32x16_bf16 v[192:207], v[72:75], v[36:39], v[192:207]
v_mfma_f32_32x32x16_bf16 v[208:223], v[72:75], v[40:43], v[208:223]
v_mfma_f32_32x32x16_bf16 v[224:239], v[76:79], v[36:39], v[224:239]
v_mfma_f32_32x32x16_bf16 v[240:255], v[76:79], v[40:43], v[240:255]
global_load_dwordx4 v[36:39], v7, s[62:63] offset:2048 sc1
global_load_dwordx4 v[40:43], v8, s[62:63] offset:2048 sc1
global_load_dwordx4 v[72:75], v7, s[62:63] offset:3072 sc1
global_load_dwordx4 v[76:79], v8, s[62:63] offset:3072 sc1
s_waitcnt vmcnt(14)
v_mfma_f32_32x32x16_bf16 v[192:207], v[80:83], v[12:15], v[192:207]
v_mfma_f32_32x32x16_bf16 v[208:223], v[80:83], v[16:19], v[208:223]
v_mfma_f32_32x32x16_bf16 v[224:239], v[84:87], v[12:15], v[224:239]
v_mfma_f32_32x32x16_bf16 v[240:255], v[84:87], v[16:19], v[240:255]
v_add_u32 v7, 4096, v7
v_add_u32 v8, 4096, v8
global_load_dwordx4 v[12:15], v7, s[62:63] offset:0 sc1
global_load_dwordx4 v[16:19], v8, s[62:63] offset:0 sc1
global_load_dwordx4 v[80:83], v7, s[62:63] offset:1024 sc1
global_load_dwordx4 v[84:87], v8, s[62:63] offset:1024 sc1
s_waitcnt vmcnt(16)
v_mfma_f32_32x32x16_bf16 v[192:207], v[88:91], v[48:51], v[192:207]
v_mfma_f32_32x32x16_bf16 v[208:223], v[88:91], v[52:55], v[208:223]
v_mfma_f32_32x32x16_bf16 v[224:239], v[92:95], v[48:51], v[224:239]
v_mfma_f32_32x32x16_bf16 v[240:255], v[92:95], v[52:55], v[240:255]
global_load_dwordx4 v[48:51], v10, s[68:69] offset:0 sc1
global_load_dwordx4 v[52:55], v11, s[68:69] offset:0 sc1
global_load_dwordx4 v[88:91], v10, s[68:69] offset:1024 sc1
global_load_dwordx4 v[92:95], v11, s[68:69] offset:1024 sc1
s_waitcnt vmcnt(18)
v_mfma_f32_32x32x16_bf16 v[192:207], v[96:99], v[20:23], v[192:207]
v_mfma_f32_32x32x16_bf16 v[208:223], v[96:99], v[24:27], v[208:223]
v_mfma_f32_32x32x16_bf16 v[224:239], v[100:103], v[20:23], v[224:239]
v_mfma_f32_32x32x16_bf16 v[240:255], v[100:103], v[24:27], v[240:255]
global_load_dwordx4 v[20:23], v10, s[68:69] offset:2048 sc1
global_load_dwordx4 v[24:27], v11, s[68:69] offset:2048 sc1
global_load_dwordx4 v[96:99], v10, s[68:69] offset:3072 sc1
global_load_dwordx4 v[100:103], v11, s[68:69] offset:3072 sc1
s_waitcnt vmcnt(20)
v_mfma_f32_32x32x16_bf16 v[192:207], v[104:107], v[56:59], v[192:207]
v_mfma_f32_32x32x16_bf16 v[208:223], v[104:107], v[60:63], v[208:223]
v_mfma_f32_32x32x16_bf16 v[224:239], v[108:111], v[56:59], v[224:239]
v_mfma_f32_32x32x16_bf16 v[240:255], v[108:111], v[60:63], v[240:255]
s_waitcnt vmcnt(18)
v_mfma_f32_32x32x16_bf16 v[192:207], v[112:115], v[28:31], v[192:207]
v_mfma_f32_32x32x16_bf16 v[208:223], v[112:115], v[32:35], v[208:223]
v_mfma_f32_32x32x16_bf16 v[224:239], v[116:119], v[28:31], v[224:239]
v_mfma_f32_32x32x16_bf16 v[240:255], v[116:119], v[32:35], v[240:255]
s_waitcnt vmcnt(16)
v_mfma_f32_32x32x16_bf16 v[192:207], v[120:123], v[64:67], v[192:207]
v_mfma_f32_32x32x16_bf16 v[208:223], v[120:123], v[68:71], v[208:223]
v_mfma_f32_32x32x16_bf16 v[224:239], v[124:127], v[64:67], v[224:239]
v_mfma_f32_32x32x16_bf16 v[240:255], v[124:127], v[68:71], v[240:255]
global_load_dword v1, v2, s[22:23] sc1
s_waitcnt vmcnt(15)
v_mfma_f32_32x32x16_bf16 v[192:207], v[128:131], v[36:39], v[192:207]
v_mfma_f32_32x32x16_bf16 v[208:223], v[128:131], v[40:43], v[208:223]
v_mfma_f32_32x32x16_bf16 v[224:239], v[132:135], v[36:39], v[224:239]
v_mfma_f32_32x32x16_bf16 v[240:255], v[132:135], v[40:43], v[240:255]
s_waitcnt vmcnt(13)
v_mfma_f32_32x32x16_bf16 v[192:207], v[136:139], v[72:75], v[192:207]
v_mfma_f32_32x32x16_bf16 v[208:223], v[136:139], v[76:79], v[208:223]
v_mfma_f32_32x32x16_bf16 v[224:239], v[140:143], v[72:75], v[224:239]
v_mfma_f32_32x32x16_bf16 v[240:255], v[140:143], v[76:79], v[240:255]
s_waitcnt vmcnt(0)
v_cmp_ne_u32 vcc, 0, v1
s_nop 3
s_not_b64 vcc, vcc
s_cmp_eq_u64 vcc, 0
s_cbranch_scc1 L_kv_readyl
s_mov_b32 s46, 0
L_poll_kvl:
global_load_dword v1, v2, s[22:23] sc1
s_waitcnt vmcnt(0)
s_add_u32 s46, s46, 1
v_cmp_ne_u32 vcc, 0, v1
s_nop 3
s_not_b64 vcc, vcc
s_cmp_eq_u64 vcc, 0
s_cbranch_scc1 L_pollok_kvl
s_cmp_lt_u32 s46, 400000
s_cbranch_scc1 L_poll_kvl
L_pollok_kvl:
L_kv_readyl:
v_lshrrev_b32 v9, 5, v0
v_and_b32 v10, 15, v0
v_lshlrev_b32 v10, 5, v10
v_lshl_add_u32 v10, v9, 9, v10
v_lshlrev_b32 v9, 5, v9
v_add_u32 v9, 1024, v9
v_and_b32 v11, 16, v0
v_cmp_eq_u32 vcc, 0, v11
s_mul_i32 s44, s24, 4608
s_add_u32 s44, s44, 9437184
v_cndmask_b32 v9, v10, v9, vcc
s_add_u32 s66, s22, s44
s_addc_u32 s67, s23, 0
global_load_dwordx4 v[104:107], v9, s[66:67] offset:0 sc1
global_load_dwordx4 v[108:111], v9, s[66:67] offset:16 sc1
global_load_dwordx4 v[112:115], v9, s[66:67] offset:1152 sc1
global_load_dwordx4 v[116:119], v9, s[66:67] offset:1168 sc1
global_load_dwordx4 v[120:123], v9, s[66:67] offset:2304 sc1
global_load_dwordx4 v[124:127], v9, s[66:67] offset:2320 sc1
global_load_dwordx4 v[128:131], v9, s[66:67] offset:3456 sc1
global_load_dwordx4 v[132:135], v9, s[66:67] offset:3472 sc1
s_waitcnt vmcnt(19)
v_mfma_f32_32x32x16_bf16 v[192:207], v[144:147], v[12:15], v[192:207]
v_mfma_f32_32x32x16_bf16 v[208:223], v[144:147], v[16:19], v[208:223]
v_mfma_f32_32x32x16_bf16 v[224:239], v[148:151], v[12:15], v[224:239]
v_mfma_f32_32x32x16_bf16 v[240:255], v[148:151], v[16:19], v[240:255]
s_waitcnt vmcnt(17)
v_mfma_f32_32x32x16_bf16 v[192:207], v[152:155], v[80:83], v[192:207]
v_mfma_f32_32x32x16_bf16 v[208:223], v[152:155], v[84:87], v[208:223]
v_mfma_f32_32x32x16_bf16 v[224:239], v[156:159], v[80:83], v[224:239]
v_mfma_f32_32x32x16_bf16 v[240:255], v[156:159], v[84:87], v[240:255]
s_mov_b32 s46, 0x358637bd
s_waitcnt vmcnt(0)
v_cvt_pk_bf16_f32 v136, v104, v105
v_cvt_pk_bf16_f32 v137, v106, v107
v_cvt_pk_bf16_f32 v138, v108, v109
v_cvt_pk_bf16_f32 v139, v110, v111
v_cvt_pk_bf16_f32 v140, v112, v113
v_cvt_pk_bf16_f32 v141, v114, v115
v_cvt_pk_bf16_f32 v142, v116, v117
v_cvt_pk_bf16_f32 v143, v118, v119
v_cvt_pk_bf16_f32 v144, v120, v121
v_cvt_pk_bf16_f32 v145, v122, v123
v_cvt_pk_bf16_f32 v146, v124, v125
v_cvt_pk_bf16_f32 v147, v126, v127
v_cvt_pk_bf16_f32 v148, v128, v129
v_cvt_pk_bf16_f32 v149, v130, v131
v_cvt_pk_bf16_f32 v150, v132, v133
v_cvt_pk_bf16_f32 v151, v134, v135
s_waitcnt vmcnt(9)
v_mfma_f32_32x32x16_bf16 v[56:71], v[136:139], v[48:51], 0
v_mfma_f32_32x32x16_bf16 v[72:87], v[136:139], v[52:55], 0
v_mfma_f32_32x32x16_bf16 v[104:119], v[140:143], v[88:91], 0
v_mfma_f32_32x32x16_bf16 v[120:135], v[140:143], v[92:95], 0
s_nop 8
v_add_f32 v9, s46, v56
v_add_f32 v10, s46, v72
v_rcp_f32 v9, v9
v_rcp_f32 v10, v10
v_mul_f32 v64, v9, v64
v_mul_f32 v65, v9, v65
v_mul_f32 v66, v9, v66
v_mul_f32 v67, v9, v67
v_mul_f32 v68, v9, v68
v_mul_f32 v69, v9, v69
v_mul_f32 v70, v9, v70
v_mul_f32 v71, v9, v71
v_mul_f32 v80, v10, v80
v_mul_f32 v81, v10, v81
v_mul_f32 v82, v10, v82
v_mul_f32 v83, v10, v83
v_mul_f32 v84, v10, v84
v_mul_f32 v85, v10, v85
v_mul_f32 v86, v10, v86
v_mul_f32 v87, v10, v87
v_cvt_pk_bf16_f32 v56, v64, v65
v_cvt_pk_bf16_f32 v57, v66, v67
v_cvt_pk_bf16_f32 v58, v68, v69
v_cvt_pk_bf16_f32 v59, v70, v71
v_cvt_pk_bf16_f32 v72, v80, v81
v_cvt_pk_bf16_f32 v73, v82, v83
v_cvt_pk_bf16_f32 v74, v84, v85
v_cvt_pk_bf16_f32 v75, v86, v87
v_mfma_f32_32x32x16_bf16 v[192:207], v[160:163], v[56:59], v[192:207]
s_nop 0
v_mfma_f32_32x32x16_bf16 v[208:223], v[160:163], v[72:75], v[208:223]
v_mfma_f32_32x32x16_bf16 v[224:239], v[164:167], v[56:59], v[224:239]
v_mfma_f32_32x32x16_bf16 v[240:255], v[164:167], v[72:75], v[240:255]
v_mfma_f32_32x32x16_bf16 v[56:71], v[144:147], v[20:23], 0
v_mfma_f32_32x32x16_bf16 v[72:87], v[144:147], v[24:27], 0
v_add_f32 v9, s46, v104
v_add_f32 v10, s46, v120
v_rcp_f32 v9, v9
v_rcp_f32 v10, v10
v_mul_f32 v112, v9, v112
v_mul_f32 v113, v9, v113
v_mul_f32 v114, v9, v114
v_mul_f32 v115, v9, v115
v_mul_f32 v116, v9, v116
v_mul_f32 v117, v9, v117
v_mul_f32 v118, v9, v118
v_mul_f32 v119, v9, v119
v_mul_f32 v128, v10, v128
v_mul_f32 v129, v10, v129
v_mul_f32 v130, v10, v130
v_mul_f32 v131, v10, v131
v_mul_f32 v132, v10, v132
v_mul_f32 v133, v10, v133
v_mul_f32 v134, v10, v134
v_mul_f32 v135, v10, v135
v_cvt_pk_bf16_f32 v104, v112, v113
v_cvt_pk_bf16_f32 v105, v114, v115
v_cvt_pk_bf16_f32 v106, v116, v117
v_cvt_pk_bf16_f32 v107, v118, v119
v_cvt_pk_bf16_f32 v120, v128, v129
v_cvt_pk_bf16_f32 v121, v130, v131
v_cvt_pk_bf16_f32 v122, v132, v133
v_cvt_pk_bf16_f32 v123, v134, v135
v_mfma_f32_32x32x16_bf16 v[192:207], v[168:171], v[104:107], v[192:207]
s_nop 0
v_mfma_f32_32x32x16_bf16 v[208:223], v[168:171], v[120:123], v[208:223]
v_mfma_f32_32x32x16_bf16 v[224:239], v[172:175], v[104:107], v[224:239]
v_mfma_f32_32x32x16_bf16 v[240:255], v[172:175], v[120:123], v[240:255]
v_mfma_f32_32x32x16_bf16 v[104:119], v[148:151], v[96:99], 0
v_mfma_f32_32x32x16_bf16 v[120:135], v[148:151], v[100:103], 0
v_add_f32 v9, s46, v56
v_add_f32 v10, s46, v72
v_rcp_f32 v9, v9
v_rcp_f32 v10, v10
v_mul_f32 v64, v9, v64
v_mul_f32 v65, v9, v65
v_mul_f32 v66, v9, v66
v_mul_f32 v67, v9, v67
v_mul_f32 v68, v9, v68
v_mul_f32 v69, v9, v69
v_mul_f32 v70, v9, v70
v_mul_f32 v71, v9, v71
v_mul_f32 v80, v10, v80
v_mul_f32 v81, v10, v81
v_mul_f32 v82, v10, v82
v_mul_f32 v83, v10, v83
v_mul_f32 v84, v10, v84
v_mul_f32 v85, v10, v85
v_mul_f32 v86, v10, v86
v_mul_f32 v87, v10, v87
v_cvt_pk_bf16_f32 v56, v64, v65
v_cvt_pk_bf16_f32 v57, v66, v67
v_cvt_pk_bf16_f32 v58, v68, v69
v_cvt_pk_bf16_f32 v59, v70, v71
v_cvt_pk_bf16_f32 v72, v80, v81
v_cvt_pk_bf16_f32 v73, v82, v83
v_cvt_pk_bf16_f32 v74, v84, v85
v_cvt_pk_bf16_f32 v75, v86, v87
v_mfma_f32_32x32x16_bf16 v[192:207], v[176:179], v[56:59], v[192:207]
s_nop 0
v_mfma_f32_32x32x16_bf16 v[208:223], v[176:179], v[72:75], v[208:223]
v_mfma_f32_32x32x16_bf16 v[224:239], v[180:183], v[56:59], v[224:239]
v_mfma_f32_32x32x16_bf16 v[240:255], v[180:183], v[72:75], v[240:255]
v_add_f32 v9, s46, v104
v_add_f32 v10, s46, v120
v_rcp_f32 v9, v9
v_rcp_f32 v10, v10
v_mul_f32 v112, v9, v112
v_mul_f32 v113, v9, v113
v_mul_f32 v114, v9, v114
v_mul_f32 v115, v9, v115
v_mul_f32 v116, v9, v116
v_mul_f32 v117, v9, v117
v_mul_f32 v118, v9, v118
v_mul_f32 v119, v9, v119
v_mul_f32 v128, v10, v128
v_mul_f32 v129, v10, v129
v_mul_f32 v130, v10, v130
v_mul_f32 v131, v10, v131
v_mul_f32 v132, v10, v132
v_mul_f32 v133, v10, v133
v_mul_f32 v134, v10, v134
v_mul_f32 v135, v10, v135
v_cvt_pk_bf16_f32 v104, v112, v113
v_cvt_pk_bf16_f32 v105, v114, v115
v_cvt_pk_bf16_f32 v106, v116, v117
v_cvt_pk_bf16_f32 v107, v118, v119
v_cvt_pk_bf16_f32 v120, v128, v129
v_cvt_pk_bf16_f32 v121, v130, v131
v_cvt_pk_bf16_f32 v122, v132, v133
v_cvt_pk_bf16_f32 v123, v134, v135
v_mfma_f32_32x32x16_bf16 v[192:207], v[184:187], v[104:107], v[192:207]
s_nop 0
v_mfma_f32_32x32x16_bf16 v[208:223], v[184:187], v[120:123], v[208:223]
v_mfma_f32_32x32x16_bf16 v[224:239], v[188:191], v[104:107], v[224:239]
v_mfma_f32_32x32x16_bf16 v[240:255], v[188:191], v[120:123], v[240:255]
v_mov_b32 v116, v44
v_mov_b32 v117, v45
v_mov_b32 v118, v46
v_mov_b32 v119, v47
s_waitcnt lgkmcnt(0)
s_barrier
s_and_b32 s45, s24, 3
s_mul_i32 s45, s45, 12288
v_lshlrev_b32 v9, 4, v0
v_add_u32 v9, s45, v9
v_add_u32 v10, 106496, v9
v_add_u32 v11, 53248, v9
ds_write_b128 v11, v[192:195] offset:0
ds_write_b128 v11, v[196:199] offset:1024
ds_write_b128 v11, v[200:203] offset:2048
ds_write_b128 v11, v[204:207] offset:3072
ds_write_b128 v11, v[224:227] offset:4096
ds_write_b128 v11, v[228:231] offset:5120
ds_write_b128 v11, v[232:235] offset:6144
ds_write_b128 v11, v[236:239] offset:7168
ds_write_b128 v9, v[208:211] offset:8192
ds_write_b128 v9, v[212:215] offset:9216
ds_write_b128 v9, v[216:219] offset:10240
ds_write_b128 v9, v[220:223] offset:11264
ds_write_b128 v10, v[240:243] offset:8192
ds_write_b128 v10, v[244:247] offset:9216
ds_write_b128 v10, v[248:251] offset:10240
ds_write_b128 v10, v[252:255] offset:11264
L_g2_fin:
s_lshl_b32 s44, s24, 10
v_lshlrev_b32 v1, 4, v0
v_add_u32 v2, s44, v1
v_add_u32 v3, 106496, v2
v_add_u32 v4, 53248, v2
s_and_b32 s44, s24, 3
s_lshl_b32 s44, s44, 10
s_add_u32 s45, s44, 8192
s_add_u32 s46, s45, 106496
s_cmp_lt_u32 s24, 4
s_cselect_b32 s45, s45, s46
v_add_u32 v5, s45, v1
v_lshlrev_b32 v100, 16, v116
v_and_b32 v101, 0xffff0000, v116
v_lshlrev_b32 v102, 16, v117
v_and_b32 v103, 0xffff0000, v117
v_lshlrev_b32 v104, 16, v118
v_and_b32 v105, 0xffff0000, v118
v_lshlrev_b32 v106, 16, v119
v_and_b32 v107, 0xffff0000, v119
v_and_b32 v8, 31, v0
v_lshlrev_b32 v8, 10, v8
v_lshrrev_b32 v6, 5, v0
v_lshl_add_u32 v8, v6, 3, v8
v_add_u32 v8, s53, v8
v_add_u32 v7, 32768, v8
s_waitcnt lgkmcnt(0)
s_barrier
ds_read_b128 v[12:15], v2 offset:0
ds_read_b128 v[16:19], v3 offset:0
ds_read_b128 v[20:23], v2 offset:12288
ds_read_b128 v[24:27], v3 offset:12288
ds_read_b128 v[28:31], v2 offset:24576
ds_read_b128 v[32:35], v3 offset:24576
ds_read_b128 v[36:39], v2 offset:36864
ds_read_b128 v[40:43], v3 offset:36864
ds_read_b128 v[44:47], v4 offset:0
ds_read_b128 v[48:51], v5 offset:0
ds_read_b128 v[52:55], v4 offset:12288
ds_read_b128 v[56:59], v5 offset:12288
ds_read_b128 v[60:63], v4 offset:24576
ds_read_b128 v[64:67], v5 offset:24576
ds_read_b128 v[68:71], v4 offset:36864
ds_read_b128 v[72:75], v5 offset:36864
s_waitcnt lgkmcnt(8)
v_pk_add_f32 v[100:101], v[100:101], v[12:13]
v_pk_add_f32 v[102:103], v[102:103], v[14:15]
v_pk_add_f32 v[104:105], v[104:105], v[16:17]
v_pk_add_f32 v[106:107], v[106:107], v[18:19]
v_pk_add_f32 v[100:101], v[100:101], v[20:21]
v_pk_add_f32 v[102:103], v[102:103], v[22:23]
v_pk_add_f32 v[104:105], v[104:105], v[24:25]
v_pk_add_f32 v[106:107], v[106:107], v[26:27]
v_pk_add_f32 v[100:101], v[100:101], v[28:29]
v_pk_add_f32 v[102:103], v[102:103], v[30:31]
v_pk_add_f32 v[104:105], v[104:105], v[32:33]
v_pk_add_f32 v[106:107], v[106:107], v[34:35]
v_pk_add_f32 v[100:101], v[100:101], v[36:37]
v_pk_add_f32 v[102:103], v[102:103], v[38:39]
v_pk_add_f32 v[104:105], v[104:105], v[40:41]
v_pk_add_f32 v[106:107], v[106:107], v[42:43]
s_waitcnt lgkmcnt(0)
v_pk_add_f32 v[100:101], v[100:101], v[44:45]
v_pk_add_f32 v[102:103], v[102:103], v[46:47]
v_pk_add_f32 v[104:105], v[104:105], v[48:49]
v_pk_add_f32 v[106:107], v[106:107], v[50:51]
v_pk_add_f32 v[100:101], v[100:101], v[52:53]
v_pk_add_f32 v[102:103], v[102:103], v[54:55]
v_pk_add_f32 v[104:105], v[104:105], v[56:57]
v_pk_add_f32 v[106:107], v[106:107], v[58:59]
v_pk_add_f32 v[100:101], v[100:101], v[60:61]
v_pk_add_f32 v[102:103], v[102:103], v[62:63]
v_pk_add_f32 v[104:105], v[104:105], v[64:65]
v_pk_add_f32 v[106:107], v[106:107], v[66:67]
v_pk_add_f32 v[100:101], v[100:101], v[68:69]
v_pk_add_f32 v[102:103], v[102:103], v[70:71]
v_pk_add_f32 v[104:105], v[104:105], v[72:73]
v_pk_add_f32 v[106:107], v[106:107], v[74:75]
v_cvt_pk_bf16_f32 v108, v100, v101
v_cvt_pk_bf16_f32 v109, v102, v103
v_cvt_pk_bf16_f32 v110, v104, v105
v_cvt_pk_bf16_f32 v111, v106, v107
global_store_dwordx2 v8, v[108:109], s[18:19]
global_store_dwordx2 v7, v[110:111], s[18:19]
L_end:
s_endpgm
.section .rodata,"a"
.p2align 6
.amdhsa_kernel parallel_sum__linear_attn_block__glu_gated_swiglu__prompt_kernel
  .amdhsa_next_free_vgpr 256
  .amdhsa_next_free_sgpr 102
  .amdhsa_accum_offset 256
  .amdhsa_group_segment_fixed_size 0
  .amdhsa_kernarg_size 80
  .amdhsa_user_sgpr_count 2
  .amdhsa_user_sgpr_kernarg_segment_ptr 1
  .amdhsa_system_sgpr_workgroup_id_x 1
  .amdhsa_float_denorm_mode_32 3
.end_amdhsa_kernel
```
